```python
import torch

def _softmax(x, axis=-1):
    return torch.softmax(x, dim=axis)
def _gelu(x):
    return torch.nn.functional.gelu(x, approximate="tanh")
def _silu(x):
    return torch.nn.functional.silu(x)
def _sigmoid(x):
    return torch.sigmoid(x)
def _layernorm(x, axis=-1, eps=1e-5):
    m = x.mean(dim=axis, keepdim=True)
    v = x.var(dim=axis, keepdim=True, unbiased=False)
    return (x - m) / torch.sqrt(v + eps)
def _scatter_add(tgt, idx, src, axis=0):
    return tgt.clone().index_add_(axis, idx, src)
def _segment_sum(src, seg, n):
    out = torch.zeros((n,) + src.shape[1:], dtype=src.dtype)
    return out.index_add_(0, seg, src)
def _pad(x, pw):
    flat = tuple(v for pair in reversed(pw) for v in pair)
    return torch.nn.functional.pad(x, flat)

kernel_name = 'recurrent_scan__ssm_conv_s5__dense_activation_mish__prompt'

def setup_inputs():

    _w = (lambda a: (lambda t: t.to(torch.bfloat16) if t.is_floating_point() else t)(torch.as_tensor(a)))
    def _A_setup():
        B, S, D = 1, 2048, 512
        P = D
        Lambda_re = -0.5 * (lambda _x: torch.exp(torch.as_tensor(_x)))((lambda *s: torch.randn(*s, dtype=torch.bfloat16) * 0.8)(P))
        Lambda_im = (lambda *s: torch.randn(*s, dtype=torch.bfloat16) * 0.8)(P) * 1.0
        B_re = (lambda *s: torch.randn(*s, dtype=torch.bfloat16) * 0.8)(P, D) * (D ** -0.5)
        B_im = (lambda *s: torch.randn(*s, dtype=torch.bfloat16) * 0.8)(P, D) * (D ** -0.5)
        C_re = (lambda *s: torch.randn(*s, dtype=torch.bfloat16) * 0.8)(D, P) * (P ** -0.5)
        C_im = (lambda *s: torch.randn(*s, dtype=torch.bfloat16) * 0.8)(D, P) * (P ** -0.5)
        log_dt = (lambda *s: torch.randn(*s, dtype=torch.bfloat16) * 0.8)(P) * 0.3 - 2.0
        Dskip = (lambda *s: torch.randn(*s, dtype=torch.bfloat16) * 0.4)(D)
        return {
            "x": _w((lambda *s: torch.randn(*s, dtype=torch.bfloat16) * 0.05)(B, S, D)),
            "Lambda_re": _w(Lambda_re),
            "Lambda_im": _w(Lambda_im),
            "B_re": _w(B_re),
            "B_im": _w(B_im),
            "C_re": _w(C_re),
            "C_im": _w(C_im),
            "log_dt": _w(log_dt),
            "Dskip": _w(Dskip),
        }
    _A_in = _A_setup()

    def _B_setup():
        B, S, D, F = 1, 2048, 512, 1792
        return {
            "x": _w((lambda *s: torch.randn(*s, dtype=torch.bfloat16) * 0.05)(B, S, D)),
            "w1": _w((lambda *s: torch.randn(*s, dtype=torch.bfloat16) * 0.8)(D, F) * (D ** -0.5)),
            "b1": _w((lambda *s: torch.randn(*s, dtype=torch.bfloat16) * 0.8)(F)),
            "w2": _w((lambda *s: torch.randn(*s, dtype=torch.bfloat16) * 0.1)(F, D) * (F ** -0.5)),
        }
    _B_in = _B_setup()

    return {
        "A_x": _A_in["x"],
        "A_Lambda_re": _A_in["Lambda_re"],
        "A_Lambda_im": _A_in["Lambda_im"],
        "A_B_re": _A_in["B_re"],
        "A_B_im": _A_in["B_im"],
        "A_C_re": _A_in["C_re"],
        "A_C_im": _A_in["C_im"],
        "A_log_dt": _A_in["log_dt"],
        "A_Dskip": _A_in["Dskip"],
        "B_x": _B_in["x"],
        "B_w1": _B_in["w1"],
        "B_b1": _B_in["b1"],
        "B_w2": _B_in["w2"],
    }

def reference(A_x, A_Lambda_re, A_Lambda_im, A_B_re, A_B_im, A_C_re, A_C_im, A_log_dt, A_Dskip, B_x, B_w1, B_b1, B_w2):
    def _A_ref(x, Lambda_re, Lambda_im, B_re, B_im, C_re, C_im, log_dt, Dskip):
        Bsz, L, H = x.shape
        Lam = Lambda_re + 1j * Lambda_im
        Bmat = B_re + 1j * B_im
        Cmat = C_re + 1j * C_im
        dt = torch.exp(log_dt)
        Lam_bar = torch.exp(dt * Lam)
        B_bar = ((Lam_bar - 1.0) / Lam)[:, None] * Bmat
        Bu = torch.einsum("bld,pd->blp", x + 0j, B_bar)
        h = torch.zeros_like(Bu[:, 0, :])
        hs = []
        for t in range(L):
            h = Lam_bar[None, :] * h + Bu[:, t, :]
            hs.append(h)
        hseq = torch.stack(hs, 1)
        y = 2.0 * torch.einsum("blp,dp->bld", hseq, Cmat).real + x * Dskip[None, None, :]
        return y

    def _B_ref(x, w1, b1, w2):
        h = torch.einsum("bsd,df->bsf", x, w1) + b1
        sp = torch.log1p(torch.exp(-torch.abs(h))) + torch.where(h > 0, h, torch.zeros_like(h))
        act = h * torch.tanh(sp)
        return torch.einsum("bsf,fd->bsd", act, w2)

    x = A_x
    xn = _layernorm(x, axis=-1)
    s = _A_ref(xn, A_Lambda_re, A_Lambda_im, A_B_re, A_B_im, A_C_re, A_C_im, A_log_dt, A_Dskip)
    g = _silu(_B_ref(xn, B_w1, B_b1, B_w2))
    return x + s * g
```

```asm
; @launch grid=(256,1,1) block=(512,1,1) lds=163840
.amdgcn_target "amdgcn-amd-amdhsa--gfx950"
.text
.globl recurrent_scan__ssm_conv_s5__dense_activation_mish__prompt_kernel
.p2align 8
.type recurrent_scan__ssm_conv_s5__dense_activation_mish__prompt_kernel,@function
recurrent_scan__ssm_conv_s5__dense_activation_mish__prompt_kernel:
    s_load_dwordx16 s[36:51], s[0:1], 0
    s_load_dwordx16 s[52:67], s[0:1], 64
    s_getpc_b64 s[34:35]
L_pc:
    s_cmp_ge_u32 s2, 256
    s_cbranch_scc1 L_end
    v_lshrrev_b32 v2, 6, v0
    s_lshr_b32 s26, s2, 3
    v_and_b32 v0, 63, v0
    v_readfirstlane_b32 s24, v2
    v_lshl_add_u32 v2, s26, 3, v2
    v_lshlrev_b32 v2, 7, v2
    v_min_u32 v2, L_end-L_pc, v2
    global_load_dword v255, v2, s[34:35]
    s_and_b32 s25, s2, 7
    s_and_b32 s20, s26, 7
    s_lshr_b32 s21, s26, 3
    s_lshr_b32 s27, s25, 2
    s_lshl3_add_u32 s27, s27, s20
    s_and_b32 s22, s25, 3
    s_lshl2_add_u32 s28, s22, s21
    s_mul_i32 s30, s20, 2
    s_mul_i32 s21, s21, 4
    s_add_u32 s30, s30, s21
    s_mul_i32 s21, s25, 2
    s_add_u32 s30, s30, s21
    s_lshr_b32 s21, s25, 2
    s_mul_i32 s21, s21, 1
    s_add_u32 s30, s30, s21
    s_and_b32 s33, s24, 3
    s_lshr_b32 s89, s33, 1
    s_cmp_ge_u32 s24, 4
    s_cbranch_scc1 L_X
    v_and_b32 v2, 31, v0
    v_lshrrev_b32 v3, 5, v0
    v_lshlrev_b32 v4, 4, v2
    v_lshl_add_u32 v4, v3, 10, v4
    s_lshl4_add_u32 s20, s27, s28
    s_lshl2_add_u32 s20, s20, s24
    s_lshl_b32 s68, s20, 11
    s_lshl_b32 s69, s20, 4
    s_waitcnt lgkmcnt(0)
    s_mov_b32 s4, s36
    s_mov_b32 s5, s37
    s_mov_b32 s6, 2097152
    s_mov_b32 s7, 0x00020000
    buffer_load_dwordx4 v[208:211], v4, s[4:7], s68 offen
    buffer_load_dwordx4 v[212:215], v4, s[4:7], s68 offen offset:512
    s_mov_b32 s16, s66
    s_mov_b32 s17, s67
    s_mov_b32 s18, 268435456
    s_mov_b32 s19, 0x00020000
    buffer_load_dword v1, off, s[16:19], 0 sc1
    s_lshr_b32 s20, s28, 2
    s_lshl_b32 s29, s28, 1
    s_sub_u32 s29, s29, s20
    s_and_b32 s87, s26, 7
    s_lshr_b32 s20, s25, 1
    s_lshl3_add_u32 s31, s20, s87
    s_and_b32 s20, s25, 1
    s_lshr_b32 s32, s26, 3
    s_lshl2_add_u32 s32, s20, s32
    s_mov_b32 s77, 400000
    s_lshl1_add_u32 s88, s27, s89
    s_mov_b32 s76, 0xffff0000
    s_mul_i32 s87, s87, 1
    s_mul_i32 s20, s25, 0
    s_add_u32 s87, s87, s20
    s_add_u32 s91, s87, 0
    s_and_b32 s91, s91, 1
    s_mul_i32 s86, s31, 360448
    s_add_u32 s86, s86, 2097152
    v_lshlrev_b32 v6, 4, v0
    v_add_u32 v7, 4096, v6
    s_add_u32 s69, s69, 4096
    v_and_b32 v2, 15, v0
    s_and_b32 s21, s33, 1
    s_lshl1_add_u32 s20, s28, s21
    s_lshl_b32 s20, s20, 4
    v_add_lshl_u32 v4, v2, s20, 1
    global_load_ushort v244, v4, s[38:39]
    global_load_ushort v245, v4, s[40:41]
    global_load_ushort v246, v4, s[50:51]
    s_lshl_b32 s20, s32, 7
    v_mov_b32 v4, s20
    global_load_dword v254, v4, s[52:53]
    s_mul_i32 s20, s88, 12
    s_lshr_b32 s22, s28, 2
    s_add_u32 s20, s20, s22
    s_add_u32 s20, s20, 8192
    s_add_u32 s22, s22, s20
    s_add_u32 s22, s22, 2
    s_lshl_b32 s20, s20, 7
    v_add_lshl_u32 v4, v0, s22, 7
    s_mov_b64 exec, 2
    v_mov_b32 v4, s20
    s_mov_b64 exec, 1
    v_mov_b32 v4, s69
    s_mov_b64 exec, 15
    buffer_load_dword v254, v4, s[16:19], 0 offen
    s_mov_b64 exec, -1
    v_and_b32 v2, 15, v0
    v_bfe_u32 v3, v0, 1, 3
    v_lshrrev_b32 v4, 4, v0
    v_xor_b32 v3, v3, v4
    v_lshlrev_b32 v3, 4, v3
    v_lshl_add_u32 v248, v2, 7, v3
    s_lshl_b32 s20, s21, 11
    s_add_u32 s20, s20, 139264
    v_add_u32 v250, s20, v248
    s_lshl_b32 s20, s89, 13
    s_add_u32 s20, s20, 8192
    v_add_u32 v248, s20, v248
    v_xor_b32 v249, 64, v248
    v_xor_b32 v251, 64, v250
    v_mov_b32 v32, 0x3f803f80
    v_mov_b32 v33, 0x3f803f80
    v_mov_b32 v34, 0x3f803f80
    v_mov_b32 v35, 0x3f803f80
    v_and_b32 v2, 15, v0
    v_lshrrev_b32 v3, 4, v0
    v_lshlrev_b32 v3, 2, v3
    v_sub_u32 v2, v2, v3
    v_mov_b32 v3, 0x3f80
    v_mov_b32 v4, 0x3f800000
    v_cmp_eq_u32 vcc, 0, v2
    v_cmp_eq_u32 s[20:21], 1, v2
    s_nop 0
    v_cndmask_b32 v36, 0, v3, vcc
    v_cndmask_b32 v36, v36, v4, s[20:21]
    v_cmp_eq_u32 vcc, 2, v2
    v_cmp_eq_u32 s[20:21], 3, v2
    s_nop 0
    v_cndmask_b32 v37, 0, v3, vcc
    v_cndmask_b32 v37, v37, v4, s[20:21]
    v_lshrrev_b32 v3, 4, v0
    s_lshl_b32 s20, s89, 8
    s_add_u32 s20, s20, 0
    v_lshl_add_u32 v252, v3, 6, s20
    s_lshl_b32 s85, s33, 13
    s_add_u32 s20, s85, 65536
    v_and_b32 v2, 15, v0
    v_bfe_u32 v3, v0, 1, 3
    v_lshrrev_b32 v4, 5, v0
    v_xor_b32 v3, v3, v4
    v_lshlrev_b32 v3, 4, v3
    v_lshl_add_u32 v2, v2, 7, v3
    v_bfe_u32 v3, v0, 4, 1
    v_lshl_add_u32 v2, v3, 3, v2
    v_add_u32 v60, s20, v2
    v_xor_b32 v61, 32, v60
    v_xor_b32 v62, 64, v60
    v_xor_b32 v63, 96, v60
    s_lshl_b32 s72, s32, 7
    v_lshrrev_b32 v2, 4, v0
    v_bfe_u32 v3, v0, 1, 3
    s_and_b32 s20, s33, 1
    v_lshl_or_b32 v4, v2, 1, s20
    v_xor_b32 v3, v3, v4
    v_mul_u32_u24 v8, 3584, v2
    v_lshl_add_u32 v8, v3, 5, v8
    v_and_b32 v4, 1, v0
    v_lshl_add_u32 v8, v4, 4, v8
    s_and_b32 s21, s28, 3
    s_cmp_eq_u32 s21, 3
    s_cselect_b32 s21, 0x40000000, 0
    v_lshrrev_b32 v3, 2, v3
    v_mul_lo_u32 v3, v3, s21
    v_add_u32 v8, v8, v3
    v_add_u32 v9, 13312, v8
    s_lshl_b32 s73, s29, 7
    s_mul_i32 s22, s33, 28672
    s_add_u32 s73, s73, s22
    s_lshl_b32 s90, s33, 11
    v_lshrrev_b32 v2, 4, v0
    v_and_b32 v3, 7, v0
    v_xor_b32 v2, v2, v3
    v_lshlrev_b32 v2, 4, v2
    v_lshrrev_b32 v3, 3, v0
    v_lshl_add_u32 v10, v3, 10, v2
    v_xor_b32 v11, 64, v10
    v_add_u32 v11, 7168, v11
    v_add_u32 v12, 14336, v10
    v_add_u32 v13, 14336, v11
    s_and_b32 s21, s33, 1
    s_lshl1_add_u32 s74, s28, s21
    s_lshl_b32 s75, s74, 14
    s_add_u32 s75, s75, 65536
    v_lshl_add_u32 v14, s21, 10, v6
    v_xor_b32 v15, 1024, v14
    v_and_b32 v2, 15, v0
    s_lshl_b32 s21, s21, 8
    s_add_u32 s21, s21, 3072
    v_lshl_add_u32 v123, v2, 3, s21
    s_lshl_b32 s21, s89, 7
    v_add_u32 v122, s21, v123
    v_lshlrev_b32 v2, 4, v2
    s_add_u32 s21, s27, 1
    s_mul_i32 s21, s21, s89
    s_lshl_b32 s21, s21, 8
    v_add_u32 v124, s21, v2
    v_lshrrev_b32 v3, 4, v0
    v_sub_u32 v3, s27, v3
    v_lshl_add_u32 v3, v3, 8, v2
    v_subrev_u32 v118, 0, v3
    v_max_i32 v118, v118, v2
    v_subrev_u32 v119, 1024, v3
    v_max_i32 v119, v119, v2
    v_subrev_u32 v120, 2048, v3
    v_max_i32 v120, v120, v2
    v_subrev_u32 v121, 3072, v3
    v_max_i32 v121, v121, v2
    s_mul_i32 s20, s33, 7
    s_and_b32 s68, s31, 1
    s_and_b32 s21, s32, 0
    s_lshl1_add_u32 s22, s21, s87
    s_add_u32 s23, s22, 0
    s_and_b32 s23, s23, 3
    s_lshl1_add_u32 s23, s23, s68
    s_min_u32 s23, s23, 6
    s_add_u32 s78, s23, s20
    s_add_u32 s23, s22, 1
    s_and_b32 s23, s23, 3
    s_lshl1_add_u32 s23, s23, s68
    s_min_u32 s23, s23, 6
    s_add_u32 s79, s23, s20
    s_add_u32 s23, s22, 2
    s_and_b32 s23, s23, 3
    s_lshl1_add_u32 s23, s23, s68
    s_min_u32 s23, s23, 6
    s_add_u32 s80, s23, s20
    s_add_u32 s23, s22, 3
    s_and_b32 s23, s23, 3
    s_lshl1_add_u32 s23, s23, s68
    s_min_u32 s23, s23, 6
    s_add_u32 s81, s23, s20
    s_add_u32 s21, s21, s87
    s_mul_i32 s22, s21, 86
    s_lshr_b32 s22, s22, 8
    s_mul_i32 s22, s22, 3
    s_sub_u32 s21, s21, s22
    s_add_u32 s20, s20, 1
    s_sub_u32 s20, s20, s68
    s_lshl1_add_u32 s82, s21, s20
    s_add_u32 s21, s21, 1
    s_cmp_eq_u32 s21, 3
    s_cselect_b32 s21, 0, s21
    s_lshl1_add_u32 s83, s21, s20
    s_add_u32 s21, s21, 1
    s_cmp_eq_u32 s21, 3
    s_cselect_b32 s21, 0, s21
    s_lshl1_add_u32 s84, s21, s20
    s_add_u32 s21, s21, 1
    s_cmp_eq_u32 s21, 3
    s_cselect_b32 s21, 0, s21
    s_mov_b32 s12, s56
    s_mov_b32 s13, s57
    s_mov_b32 s14, 1835008
    s_mov_b32 s15, 0x00020000
    s_mov_b32 s8, s60
    s_mov_b32 s9, s61
    s_mov_b32 s10, 1835008
    s_mov_b32 s11, 0x00020000
    s_mov_b32 s6, 524288
    s_lshl1_add_u32 s68, s33, s91
    s_lshl_b32 s68, s68, 7
    s_lshl_b32 s21, s32, 16
    s_add_u32 s68, s68, s21
    s_waitcnt vmcnt(5)
    s_mov_b32 s20, 0x9E3779B1
    v_mul_lo_u32 v1, v1, s20
    v_add_u32 v1, 0x7F4A7C15, v1
    v_lshlrev_b32 v216, 16, v208
    v_and_b32 v217, s76, v208
    v_lshlrev_b32 v218, 16, v209
    v_and_b32 v219, s76, v209
    v_lshlrev_b32 v220, 16, v210
    v_and_b32 v221, s76, v210
    v_lshlrev_b32 v222, 16, v211
    v_and_b32 v223, s76, v211
    v_lshlrev_b32 v224, 16, v212
    v_and_b32 v225, s76, v212
    v_lshlrev_b32 v226, 16, v213
    v_and_b32 v227, s76, v213
    v_lshlrev_b32 v228, 16, v214
    v_and_b32 v229, s76, v214
    v_lshlrev_b32 v230, 16, v215
    v_and_b32 v231, s76, v215
    v_pk_add_f32 v[232:233], v[216:217], v[218:219]
    v_pk_add_f32 v[232:233], v[232:233], v[220:221]
    v_pk_add_f32 v[232:233], v[232:233], v[222:223]
    v_pk_add_f32 v[232:233], v[232:233], v[224:225]
    v_pk_add_f32 v[232:233], v[232:233], v[226:227]
    v_pk_add_f32 v[232:233], v[232:233], v[228:229]
    v_pk_add_f32 v[232:233], v[232:233], v[230:231]
    v_add_f32 v232, v232, v233
    s_nop 1
    v_add_f32_dpp v232, v232, v232 row_ror:8 row_mask:0xf bank_mask:0xf
    s_nop 1
    v_add_f32_dpp v232, v232, v232 row_ror:4 row_mask:0xf bank_mask:0xf
    s_nop 1
    v_add_f32_dpp v232, v232, v232 row_ror:2 row_mask:0xf bank_mask:0xf
    s_nop 1
    v_add_f32_dpp v232, v232, v232 row_ror:1 row_mask:0xf bank_mask:0xf
    v_mov_b32 v233, v232
    s_nop 1
    v_permlane16_swap_b32 v232, v233
    s_nop 1
    v_add_f32 v232, v232, v233
    v_mul_f32 v232, 0x3b000000, v232
    v_pk_add_f32 v[216:217], v[216:217], v[232:233] op_sel_hi:[1,0] neg_lo:[0,1] neg_hi:[0,1]
    v_pk_add_f32 v[218:219], v[218:219], v[232:233] op_sel_hi:[1,0] neg_lo:[0,1] neg_hi:[0,1]
    v_pk_add_f32 v[220:221], v[220:221], v[232:233] op_sel_hi:[1,0] neg_lo:[0,1] neg_hi:[0,1]
    v_pk_add_f32 v[222:223], v[222:223], v[232:233] op_sel_hi:[1,0] neg_lo:[0,1] neg_hi:[0,1]
    v_pk_add_f32 v[224:225], v[224:225], v[232:233] op_sel_hi:[1,0] neg_lo:[0,1] neg_hi:[0,1]
    v_pk_add_f32 v[226:227], v[226:227], v[232:233] op_sel_hi:[1,0] neg_lo:[0,1] neg_hi:[0,1]
    v_pk_add_f32 v[228:229], v[228:229], v[232:233] op_sel_hi:[1,0] neg_lo:[0,1] neg_hi:[0,1]
    v_pk_add_f32 v[230:231], v[230:231], v[232:233] op_sel_hi:[1,0] neg_lo:[0,1] neg_hi:[0,1]
    v_pk_mul_f32 v[234:235], v[216:217], v[216:217]
    v_pk_fma_f32 v[234:235], v[218:219], v[218:219], v[234:235]
    v_pk_fma_f32 v[234:235], v[220:221], v[220:221], v[234:235]
    v_pk_fma_f32 v[234:235], v[222:223], v[222:223], v[234:235]
    v_pk_fma_f32 v[234:235], v[224:225], v[224:225], v[234:235]
    v_pk_fma_f32 v[234:235], v[226:227], v[226:227], v[234:235]
    v_pk_fma_f32 v[234:235], v[228:229], v[228:229], v[234:235]
    v_pk_fma_f32 v[234:235], v[230:231], v[230:231], v[234:235]
    v_add_f32 v234, v234, v235
    s_nop 1
    v_add_f32_dpp v234, v234, v234 row_ror:8 row_mask:0xf bank_mask:0xf
    s_nop 1
    v_add_f32_dpp v234, v234, v234 row_ror:4 row_mask:0xf bank_mask:0xf
    s_nop 1
    v_add_f32_dpp v234, v234, v234 row_ror:2 row_mask:0xf bank_mask:0xf
    s_nop 1
    v_add_f32_dpp v234, v234, v234 row_ror:1 row_mask:0xf bank_mask:0xf
    v_mov_b32 v235, v234
    s_nop 1
    v_permlane16_swap_b32 v234, v235
    s_nop 1
    v_add_f32 v234, v234, v235
    v_mul_f32 v234, 0x3b000000, v234
    v_cvt_pk_bf16_f32 v234, v234, v234
    v_and_b32 v234, s76, v234
    v_add_f32 v234, 0x3727c5ac, v234
    v_cvt_pk_bf16_f32 v234, v234, v234
    v_and_b32 v234, s76, v234
    v_sqrt_f32 v234, v234
    v_lshrrev_b32 v3, 5, v0
    v_cvt_pk_bf16_f32 v232, v232, v234
    v_mov_b32 v233, v1
    v_lshlrev_b32 v3, 3, v3
    s_mov_b32 exec_lo, 1
    s_mov_b32 exec_hi, 1
    buffer_store_dwordx2 v[232:233], v3, s[16:19], s69 offen sc1
    s_mov_b64 exec, -1
    s_waitcnt lgkmcnt(0)
    s_barrier
    ds_read_b128 v[144:147], v250 offset:0
    ds_read_b128 v[148:151], v250 offset:4096
    ds_read_b128 v[128:131], v248 offset:0
    ds_read_b128 v[132:135], v248 offset:2048
    ds_read_b128 v[136:139], v248 offset:4096
    ds_read_b128 v[140:143], v248 offset:6144
    s_waitcnt lgkmcnt(4)
    v_mfma_f32_16x16x32_bf16 v[40:43], v[32:35], v[144:147], 0
    ds_read_b128 v[168:171], v251 offset:0
    v_mfma_f32_16x16x32_bf16 v[44:47], v[32:35], v[148:151], 0
    ds_read_b128 v[172:175], v251 offset:4096
    s_waitcnt lgkmcnt(5)
    v_mfma_f32_16x16x32_bf16 v[64:67], v[128:131], v[144:147], 0
    ds_read_b128 v[152:155], v249 offset:0
    v_mfma_f32_16x16x32_bf16 v[80:83], v[128:131], v[148:151], 0
    s_waitcnt lgkmcnt(5)
    v_mfma_f32_16x16x32_bf16 v[68:71], v[132:135], v[144:147], 0
    ds_read_b128 v[156:159], v249 offset:2048
    v_mfma_f32_16x16x32_bf16 v[84:87], v[132:135], v[148:151], 0
    s_waitcnt lgkmcnt(5)
    v_mfma_f32_16x16x32_bf16 v[72:75], v[136:139], v[144:147], 0
    ds_read_b128 v[160:163], v249 offset:4096
    v_mfma_f32_16x16x32_bf16 v[88:91], v[136:139], v[148:151], 0
    s_waitcnt lgkmcnt(5)
    v_mfma_f32_16x16x32_bf16 v[76:79], v[140:143], v[144:147], 0
    ds_read_b128 v[164:167], v249 offset:6144
    v_mfma_f32_16x16x32_bf16 v[92:95], v[140:143], v[148:151], 0
    s_waitcnt lgkmcnt(4)
    v_mfma_f32_16x16x32_bf16 v[40:43], v[32:35], v[168:171], v[40:43]
    v_mfma_f32_16x16x32_bf16 v[44:47], v[32:35], v[172:175], v[44:47]
    s_waitcnt vmcnt(1)
    v_mov_b32 v58, v1
    v_mov_b32 v59, v1
    v_lshlrev_b32 v244, 16, v244
    v_lshlrev_b32 v245, 16, v245
    v_lshlrev_b32 v246, 16, v246
    v_mul_f32 v246, 1069066811, v246
    v_exp_f32 v246, v246
    s_nop 0
    v_cvt_pk_bf16_f32 v246, v246, v246
    v_and_b32 v246, s76, v246
    v_mul_f32 v208, v246, v244
    v_mul_f32 v209, v246, v245
    v_mul_f32 v208, 1069066811, v208
    v_mul_f32 v209, 0.15915494, v209
    v_exp_f32 v208, v208
    v_rndne_f32 v210, v209
    v_sub_f32 v209, v209, v210
    v_cos_f32 v210, v209
    v_sin_f32 v211, v209
    v_mul_f32 v212, v244, v244
    v_fmac_f32 v212, v245, v245
    v_rcp_f32 v212, v212
    v_mul_f32 v18, v208, v210
    v_mul_f32 v211, v208, v211
    v_sub_f32 v19, 0, v211
    s_barrier
    ds_read_b128 v[144:147], v250 offset:8192
    ds_read_b128 v[148:151], v250 offset:12288
    s_waitcnt lgkmcnt(5)
    v_mfma_f32_16x16x32_bf16 v[64:67], v[152:155], v[168:171], v[64:67]
    ds_read_b128 v[128:131], v248 offset:16384
    v_mfma_f32_16x16x32_bf16 v[80:83], v[152:155], v[172:175], v[80:83]
    s_waitcnt lgkmcnt(5)
    v_mfma_f32_16x16x32_bf16 v[68:71], v[156:159], v[168:171], v[68:71]
    ds_read_b128 v[132:135], v248 offset:18432
    v_mfma_f32_16x16x32_bf16 v[84:87], v[156:159], v[172:175], v[84:87]
    s_waitcnt lgkmcnt(5)
    v_mfma_f32_16x16x32_bf16 v[72:75], v[160:163], v[168:171], v[72:75]
    ds_read_b128 v[136:139], v248 offset:20480
    v_mfma_f32_16x16x32_bf16 v[88:91], v[160:163], v[172:175], v[88:91]
    s_waitcnt lgkmcnt(5)
    v_mfma_f32_16x16x32_bf16 v[76:79], v[164:167], v[168:171], v[76:79]
    ds_read_b128 v[140:143], v248 offset:22528
    v_mfma_f32_16x16x32_bf16 v[92:95], v[164:167], v[172:175], v[92:95]
    s_waitcnt lgkmcnt(4)
    v_mfma_f32_16x16x32_bf16 v[40:43], v[32:35], v[144:147], v[40:43]
    ds_read_b128 v[168:171], v251 offset:8192
    v_mfma_f32_16x16x32_bf16 v[44:47], v[32:35], v[148:151], v[44:47]
    ds_read_b128 v[172:175], v251 offset:12288
    s_waitcnt lgkmcnt(5)
    v_mfma_f32_16x16x32_bf16 v[64:67], v[128:131], v[144:147], v[64:67]
    ds_read_b128 v[152:155], v249 offset:16384
    v_mfma_f32_16x16x32_bf16 v[80:83], v[128:131], v[148:151], v[80:83]
    s_waitcnt lgkmcnt(5)
    v_mfma_f32_16x16x32_bf16 v[68:71], v[132:135], v[144:147], v[68:71]
    ds_read_b128 v[156:159], v249 offset:18432
    v_mfma_f32_16x16x32_bf16 v[84:87], v[132:135], v[148:151], v[84:87]
    s_waitcnt lgkmcnt(5)
    v_mfma_f32_16x16x32_bf16 v[72:75], v[136:139], v[144:147], v[72:75]
    ds_read_b128 v[160:163], v249 offset:20480
    v_mfma_f32_16x16x32_bf16 v[88:91], v[136:139], v[148:151], v[88:91]
    s_waitcnt lgkmcnt(5)
    v_mfma_f32_16x16x32_bf16 v[76:79], v[140:143], v[144:147], v[76:79]
    ds_read_b128 v[164:167], v249 offset:22528
    v_mfma_f32_16x16x32_bf16 v[92:95], v[140:143], v[148:151], v[92:95]
    s_waitcnt lgkmcnt(4)
    v_mfma_f32_16x16x32_bf16 v[40:43], v[32:35], v[168:171], v[40:43]
    v_mfma_f32_16x16x32_bf16 v[44:47], v[32:35], v[172:175], v[44:47]
    v_add_f32 v210, -1.0, v18
    v_add_f32 v212, v212, v212
    v_mul_f32 v16, v210, v244
    v_fmac_f32 v16, v211, v245
    v_mul_f32 v17, v211, v244
    v_fma_f32 v17, -v210, v245, v17
    v_mul_f32 v16, v16, v212
    v_mul_f32 v17, v17, v212
    v_and_b32 v2, 16, v0
    v_cmp_ne_u32 s[42:43], 0, v2
    v_cmp_le_u32 s[44:45], 32, v0
    v_pk_mul_f32 v[214:215], v[18:19], v[18:19] op_sel_hi:[0,1]
    v_pk_fma_f32 v[214:215], v[18:19], v[18:19], v[214:215] op_sel:[1,1,0] op_sel_hi:[1,0,1] neg_lo:[0,1,0]
    v_pk_mul_f32 v[216:217], v[214:215], v[214:215] op_sel_hi:[0,1]
    v_pk_fma_f32 v[216:217], v[214:215], v[214:215], v[216:217] op_sel:[1,1,0] op_sel_hi:[1,0,1] neg_lo:[0,1,0]
    v_pk_mul_f32 v[214:215], v[216:217], v[216:217] op_sel_hi:[0,1]
    v_pk_fma_f32 v[214:215], v[216:217], v[216:217], v[214:215] op_sel:[1,1,0] op_sel_hi:[1,0,1] neg_lo:[0,1,0]
    v_pk_mul_f32 v[20:21], v[214:215], v[214:215] op_sel_hi:[0,1]
    v_pk_fma_f32 v[20:21], v[214:215], v[214:215], v[20:21] op_sel:[1,1,0] op_sel_hi:[1,0,1] neg_lo:[0,1,0]
    v_pk_mul_f32 v[214:215], v[20:21], v[20:21] op_sel_hi:[0,1]
    v_pk_fma_f32 v[214:215], v[20:21], v[20:21], v[214:215] op_sel:[1,1,0] op_sel_hi:[1,0,1] neg_lo:[0,1,0]
    v_cndmask_b32 v218, 1.0, v20, s[42:43]
    v_cndmask_b32 v219, 0, v21, s[42:43]
    v_cndmask_b32 v220, 1.0, v214, s[44:45]
    v_cndmask_b32 v221, 0, v215, s[44:45]
    s_barrier
    ds_read_b128 v[144:147], v250 offset:16384
    ds_read_b128 v[148:151], v250 offset:20480
    s_waitcnt lgkmcnt(5)
    v_mfma_f32_16x16x32_bf16 v[64:67], v[152:155], v[168:171], v[64:67]
    ds_read_b128 v[128:131], v248 offset:32768
    v_mfma_f32_16x16x32_bf16 v[80:83], v[152:155], v[172:175], v[80:83]
    s_waitcnt lgkmcnt(5)
    v_mfma_f32_16x16x32_bf16 v[68:71], v[156:159], v[168:171], v[68:71]
    ds_read_b128 v[132:135], v248 offset:34816
    v_mfma_f32_16x16x32_bf16 v[84:87], v[156:159], v[172:175], v[84:87]
    s_waitcnt lgkmcnt(5)
    v_mfma_f32_16x16x32_bf16 v[72:75], v[160:163], v[168:171], v[72:75]
    ds_read_b128 v[136:139], v248 offset:36864
    v_mfma_f32_16x16x32_bf16 v[88:91], v[160:163], v[172:175], v[88:91]
    s_waitcnt lgkmcnt(5)
    v_mfma_f32_16x16x32_bf16 v[76:79], v[164:167], v[168:171], v[76:79]
    ds_read_b128 v[140:143], v248 offset:38912
    v_mfma_f32_16x16x32_bf16 v[92:95], v[164:167], v[172:175], v[92:95]
    s_waitcnt lgkmcnt(4)
    v_mfma_f32_16x16x32_bf16 v[40:43], v[32:35], v[144:147], v[40:43]
    ds_read_b128 v[168:171], v251 offset:16384
    v_mfma_f32_16x16x32_bf16 v[44:47], v[32:35], v[148:151], v[44:47]
    ds_read_b128 v[172:175], v251 offset:20480
    s_waitcnt lgkmcnt(5)
    v_mfma_f32_16x16x32_bf16 v[64:67], v[128:131], v[144:147], v[64:67]
    ds_read_b128 v[152:155], v249 offset:32768
    v_mfma_f32_16x16x32_bf16 v[80:83], v[128:131], v[148:151], v[80:83]
    s_waitcnt lgkmcnt(5)
    v_mfma_f32_16x16x32_bf16 v[68:71], v[132:135], v[144:147], v[68:71]
    ds_read_b128 v[156:159], v249 offset:34816
    v_mfma_f32_16x16x32_bf16 v[84:87], v[132:135], v[148:151], v[84:87]
    s_waitcnt lgkmcnt(5)
    v_mfma_f32_16x16x32_bf16 v[72:75], v[136:139], v[144:147], v[72:75]
    ds_read_b128 v[160:163], v249 offset:36864
    v_mfma_f32_16x16x32_bf16 v[88:91], v[136:139], v[148:151], v[88:91]
    s_waitcnt lgkmcnt(5)
    v_mfma_f32_16x16x32_bf16 v[76:79], v[140:143], v[144:147], v[76:79]
    ds_read_b128 v[164:167], v249 offset:38912
    v_mfma_f32_16x16x32_bf16 v[92:95], v[140:143], v[148:151], v[92:95]
    s_waitcnt lgkmcnt(4)
    v_mfma_f32_16x16x32_bf16 v[40:43], v[32:35], v[168:171], v[40:43]
    v_mfma_f32_16x16x32_bf16 v[44:47], v[32:35], v[172:175], v[44:47]
    v_pk_mul_f32 v[22:23], v[218:219], v[220:221] op_sel_hi:[0,1]
    v_pk_fma_f32 v[22:23], v[218:219], v[220:221], v[22:23] op_sel:[1,1,0] op_sel_hi:[1,0,1] neg_lo:[0,1,0]
    v_pk_mul_f32 v[30:31], v[214:215], v[214:215] op_sel_hi:[0,1]
    v_pk_fma_f32 v[30:31], v[214:215], v[214:215], v[30:31] op_sel:[1,1,0] op_sel_hi:[1,0,1] neg_lo:[0,1,0]
    s_cmp_eq_u32 s89, 0
    s_cselect_b64 vcc, -1, 0
    s_cselect_b32 s59, 0, 1.0
    v_cndmask_b32_e64 v218, v30, 1.0, vcc
    v_cndmask_b32_e64 v219, v31, 0, vcc
    v_pk_mul_f32 v[126:127], v[218:219], v[22:23] op_sel_hi:[0,1]
    v_pk_fma_f32 v[126:127], v[218:219], v[22:23], v[126:127] op_sel:[1,1,0] op_sel_hi:[1,0,1] neg_lo:[0,1,0]
    v_pk_mul_f32 v[214:215], v[30:31], v[30:31] op_sel_hi:[0,1]
    v_pk_fma_f32 v[214:215], v[30:31], v[30:31], v[214:215] op_sel:[1,1,0] op_sel_hi:[1,0,1] neg_lo:[0,1,0]
    v_pk_mul_f32 v[216:217], v[214:215], v[214:215] op_sel_hi:[0,1]
    v_pk_fma_f32 v[216:217], v[214:215], v[214:215], v[216:217] op_sel:[1,1,0] op_sel_hi:[1,0,1] neg_lo:[0,1,0]
    v_cndmask_b32 v218, 1.0, v214, s[42:43]
    v_cndmask_b32 v219, 0, v215, s[42:43]
    v_cndmask_b32 v220, 1.0, v216, s[44:45]
    v_cndmask_b32 v221, 0, v217, s[44:45]
    v_pk_mul_f32 v[24:25], v[218:219], v[220:221] op_sel_hi:[0,1]
    v_pk_fma_f32 v[24:25], v[218:219], v[220:221], v[24:25] op_sel:[1,1,0] op_sel_hi:[1,0,1] neg_lo:[0,1,0]
    v_pk_mul_f32 v[26:27], v[216:217], v[216:217] op_sel_hi:[0,1]
    v_pk_fma_f32 v[26:27], v[216:217], v[216:217], v[26:27] op_sel:[1,1,0] op_sel_hi:[1,0,1] neg_lo:[0,1,0]
    v_sub_f32 v38, 0, v19
    v_sub_f32 v39, 0, v27
    s_barrier
    ds_read_b128 v[144:147], v250 offset:0
    ds_read_b128 v[148:151], v250 offset:4096
    s_waitcnt lgkmcnt(5)
    v_mfma_f32_16x16x32_bf16 v[64:67], v[152:155], v[168:171], v[64:67]
    ds_read_b128 v[128:131], v248 offset:49152
    v_mfma_f32_16x16x32_bf16 v[80:83], v[152:155], v[172:175], v[80:83]
    s_waitcnt lgkmcnt(5)
    v_mfma_f32_16x16x32_bf16 v[68:71], v[156:159], v[168:171], v[68:71]
    ds_read_b128 v[132:135], v248 offset:51200
    v_mfma_f32_16x16x32_bf16 v[84:87], v[156:159], v[172:175], v[84:87]
    s_waitcnt lgkmcnt(5)
    v_mfma_f32_16x16x32_bf16 v[72:75], v[160:163], v[168:171], v[72:75]
    ds_read_b128 v[136:139], v248 offset:53248
    v_mfma_f32_16x16x32_bf16 v[88:91], v[160:163], v[172:175], v[88:91]
    s_waitcnt lgkmcnt(5)
    v_mfma_f32_16x16x32_bf16 v[76:79], v[164:167], v[168:171], v[76:79]
    ds_read_b128 v[140:143], v248 offset:55296
    v_mfma_f32_16x16x32_bf16 v[92:95], v[164:167], v[172:175], v[92:95]
    s_waitcnt lgkmcnt(4)
    v_mfma_f32_16x16x32_bf16 v[40:43], v[32:35], v[144:147], v[40:43]
    ds_read_b128 v[168:171], v251 offset:0
    v_mfma_f32_16x16x32_bf16 v[44:47], v[32:35], v[148:151], v[44:47]
    ds_read_b128 v[172:175], v251 offset:4096
    s_waitcnt lgkmcnt(5)
    v_mfma_f32_16x16x32_bf16 v[64:67], v[128:131], v[144:147], v[64:67]
    ds_read_b128 v[152:155], v249 offset:49152
    v_mfma_f32_16x16x32_bf16 v[80:83], v[128:131], v[148:151], v[80:83]
    s_waitcnt lgkmcnt(5)
    v_mfma_f32_16x16x32_bf16 v[68:71], v[132:135], v[144:147], v[68:71]
    ds_read_b128 v[156:159], v249 offset:51200
    v_mfma_f32_16x16x32_bf16 v[84:87], v[132:135], v[148:151], v[84:87]
    s_waitcnt lgkmcnt(5)
    v_mfma_f32_16x16x32_bf16 v[72:75], v[136:139], v[144:147], v[72:75]
    ds_read_b128 v[160:163], v249 offset:53248
    v_mfma_f32_16x16x32_bf16 v[88:91], v[136:139], v[148:151], v[88:91]
    s_waitcnt lgkmcnt(5)
    v_mfma_f32_16x16x32_bf16 v[76:79], v[140:143], v[144:147], v[76:79]
    ds_read_b128 v[164:167], v249 offset:55296
    v_mfma_f32_16x16x32_bf16 v[92:95], v[140:143], v[148:151], v[92:95]
    s_waitcnt lgkmcnt(4)
    v_mfma_f32_16x16x32_bf16 v[40:43], v[32:35], v[168:171], v[40:43]
    v_mfma_f32_16x16x32_bf16 v[44:47], v[32:35], v[172:175], v[44:47]
    s_barrier
    v_add_u32 v248, 65536, v248
    ds_read_b128 v[144:147], v250 offset:8192
    ds_read_b128 v[148:151], v250 offset:12288
    s_waitcnt lgkmcnt(5)
    v_mfma_f32_16x16x32_bf16 v[64:67], v[152:155], v[168:171], v[64:67]
    ds_read_b128 v[128:131], v248 offset:0
    v_mfma_f32_16x16x32_bf16 v[80:83], v[152:155], v[172:175], v[80:83]
    s_waitcnt lgkmcnt(5)
    v_mfma_f32_16x16x32_bf16 v[68:71], v[156:159], v[168:171], v[68:71]
    ds_read_b128 v[132:135], v248 offset:2048
    v_mfma_f32_16x16x32_bf16 v[84:87], v[156:159], v[172:175], v[84:87]
    s_waitcnt lgkmcnt(5)
    v_mfma_f32_16x16x32_bf16 v[72:75], v[160:163], v[168:171], v[72:75]
    ds_read_b128 v[136:139], v248 offset:4096
    v_mfma_f32_16x16x32_bf16 v[88:91], v[160:163], v[172:175], v[88:91]
    s_waitcnt lgkmcnt(5)
    v_mfma_f32_16x16x32_bf16 v[76:79], v[164:167], v[168:171], v[76:79]
    ds_read_b128 v[140:143], v248 offset:6144
    v_mfma_f32_16x16x32_bf16 v[92:95], v[164:167], v[172:175], v[92:95]
    s_waitcnt lgkmcnt(4)
    v_mfma_f32_16x16x32_bf16 v[40:43], v[32:35], v[144:147], v[40:43]
    v_add_u32 v249, 65536, v249
    ds_read_b128 v[168:171], v251 offset:8192
    v_mfma_f32_16x16x32_bf16 v[44:47], v[32:35], v[148:151], v[44:47]
    ds_read_b128 v[172:175], v251 offset:12288
    s_waitcnt lgkmcnt(5)
    v_mfma_f32_16x16x32_bf16 v[64:67], v[128:131], v[144:147], v[64:67]
    ds_read_b128 v[152:155], v249 offset:0
    v_mfma_f32_16x16x32_bf16 v[80:83], v[128:131], v[148:151], v[80:83]
    s_waitcnt lgkmcnt(5)
    v_mfma_f32_16x16x32_bf16 v[68:71], v[132:135], v[144:147], v[68:71]
    ds_read_b128 v[156:159], v249 offset:2048
    v_mfma_f32_16x16x32_bf16 v[84:87], v[132:135], v[148:151], v[84:87]
    s_waitcnt lgkmcnt(5)
    v_mfma_f32_16x16x32_bf16 v[72:75], v[136:139], v[144:147], v[72:75]
    ds_read_b128 v[160:163], v249 offset:4096
    v_mfma_f32_16x16x32_bf16 v[88:91], v[136:139], v[148:151], v[88:91]
    s_waitcnt lgkmcnt(5)
    v_mfma_f32_16x16x32_bf16 v[76:79], v[140:143], v[144:147], v[76:79]
    ds_read_b128 v[164:167], v249 offset:6144
    v_mfma_f32_16x16x32_bf16 v[92:95], v[140:143], v[148:151], v[92:95]
    s_waitcnt lgkmcnt(4)
    v_mfma_f32_16x16x32_bf16 v[40:43], v[32:35], v[168:171], v[40:43]
    v_mfma_f32_16x16x32_bf16 v[44:47], v[32:35], v[172:175], v[44:47]
    s_barrier
    ds_read_b128 v[144:147], v250 offset:16384
    ds_read_b128 v[148:151], v250 offset:20480
    s_waitcnt lgkmcnt(5)
    v_mfma_f32_16x16x32_bf16 v[64:67], v[152:155], v[168:171], v[64:67]
    ds_read_b128 v[128:131], v248 offset:16384
    v_mfma_f32_16x16x32_bf16 v[80:83], v[152:155], v[172:175], v[80:83]
    s_waitcnt lgkmcnt(5)
    v_mfma_f32_16x16x32_bf16 v[68:71], v[156:159], v[168:171], v[68:71]
    ds_read_b128 v[132:135], v248 offset:18432
    v_mfma_f32_16x16x32_bf16 v[84:87], v[156:159], v[172:175], v[84:87]
    s_waitcnt lgkmcnt(5)
    v_mfma_f32_16x16x32_bf16 v[72:75], v[160:163], v[168:171], v[72:75]
    ds_read_b128 v[136:139], v248 offset:20480
    v_mfma_f32_16x16x32_bf16 v[88:91], v[160:163], v[172:175], v[88:91]
    s_waitcnt lgkmcnt(5)
    v_mfma_f32_16x16x32_bf16 v[76:79], v[164:167], v[168:171], v[76:79]
    ds_read_b128 v[140:143], v248 offset:22528
    v_mfma_f32_16x16x32_bf16 v[92:95], v[164:167], v[172:175], v[92:95]
    s_waitcnt lgkmcnt(4)
    v_mfma_f32_16x16x32_bf16 v[40:43], v[32:35], v[144:147], v[40:43]
    ds_read_b128 v[168:171], v251 offset:16384
    v_mfma_f32_16x16x32_bf16 v[44:47], v[32:35], v[148:151], v[44:47]
    ds_read_b128 v[172:175], v251 offset:20480
    s_waitcnt lgkmcnt(5)
    v_mfma_f32_16x16x32_bf16 v[64:67], v[128:131], v[144:147], v[64:67]
    ds_read_b128 v[152:155], v249 offset:16384
    v_mfma_f32_16x16x32_bf16 v[80:83], v[128:131], v[148:151], v[80:83]
    s_waitcnt lgkmcnt(5)
    v_mfma_f32_16x16x32_bf16 v[68:71], v[132:135], v[144:147], v[68:71]
    ds_read_b128 v[156:159], v249 offset:18432
    v_mfma_f32_16x16x32_bf16 v[84:87], v[132:135], v[148:151], v[84:87]
    s_waitcnt lgkmcnt(5)
    v_mfma_f32_16x16x32_bf16 v[72:75], v[136:139], v[144:147], v[72:75]
    ds_read_b128 v[160:163], v249 offset:20480
    v_mfma_f32_16x16x32_bf16 v[88:91], v[136:139], v[148:151], v[88:91]
    s_waitcnt lgkmcnt(5)
    v_mfma_f32_16x16x32_bf16 v[76:79], v[140:143], v[144:147], v[76:79]
    ds_read_b128 v[164:167], v249 offset:22528
    v_mfma_f32_16x16x32_bf16 v[92:95], v[140:143], v[148:151], v[92:95]
    s_waitcnt lgkmcnt(4)
    v_mfma_f32_16x16x32_bf16 v[40:43], v[32:35], v[168:171], v[40:43]
    v_mfma_f32_16x16x32_bf16 v[44:47], v[32:35], v[172:175], v[44:47]
    s_barrier
    ds_read_b128 v[144:147], v250 offset:0
    ds_read_b128 v[148:151], v250 offset:4096
    s_waitcnt lgkmcnt(5)
    v_mfma_f32_16x16x32_bf16 v[64:67], v[152:155], v[168:171], v[64:67]
    ds_read_b128 v[128:131], v248 offset:32768
    v_mfma_f32_16x16x32_bf16 v[80:83], v[152:155], v[172:175], v[80:83]
    s_waitcnt lgkmcnt(5)
    v_mfma_f32_16x16x32_bf16 v[68:71], v[156:159], v[168:171], v[68:71]
    ds_read_b128 v[132:135], v248 offset:34816
    v_mfma_f32_16x16x32_bf16 v[84:87], v[156:159], v[172:175], v[84:87]
    s_waitcnt lgkmcnt(5)
    v_mfma_f32_16x16x32_bf16 v[72:75], v[160:163], v[168:171], v[72:75]
    ds_read_b128 v[136:139], v248 offset:36864
    v_mfma_f32_16x16x32_bf16 v[88:91], v[160:163], v[172:175], v[88:91]
    s_waitcnt lgkmcnt(5)
    v_mfma_f32_16x16x32_bf16 v[76:79], v[164:167], v[168:171], v[76:79]
    ds_read_b128 v[140:143], v248 offset:38912
    v_mfma_f32_16x16x32_bf16 v[92:95], v[164:167], v[172:175], v[92:95]
    s_waitcnt lgkmcnt(4)
    v_mfma_f32_16x16x32_bf16 v[40:43], v[32:35], v[144:147], v[40:43]
    ds_read_b128 v[168:171], v251 offset:0
    v_mfma_f32_16x16x32_bf16 v[44:47], v[32:35], v[148:151], v[44:47]
    ds_read_b128 v[172:175], v251 offset:4096
    s_waitcnt lgkmcnt(5)
    v_mfma_f32_16x16x32_bf16 v[64:67], v[128:131], v[144:147], v[64:67]
    ds_read_b128 v[152:155], v249 offset:32768
    v_mfma_f32_16x16x32_bf16 v[80:83], v[128:131], v[148:151], v[80:83]
    s_waitcnt lgkmcnt(5)
    v_mfma_f32_16x16x32_bf16 v[68:71], v[132:135], v[144:147], v[68:71]
    ds_read_b128 v[156:159], v249 offset:34816
    v_mfma_f32_16x16x32_bf16 v[84:87], v[132:135], v[148:151], v[84:87]
    s_waitcnt lgkmcnt(5)
    v_mfma_f32_16x16x32_bf16 v[72:75], v[136:139], v[144:147], v[72:75]
    ds_read_b128 v[160:163], v249 offset:36864
    v_mfma_f32_16x16x32_bf16 v[88:91], v[136:139], v[148:151], v[88:91]
    s_waitcnt lgkmcnt(5)
    v_mfma_f32_16x16x32_bf16 v[76:79], v[140:143], v[144:147], v[76:79]
    ds_read_b128 v[164:167], v249 offset:38912
    v_mfma_f32_16x16x32_bf16 v[92:95], v[140:143], v[148:151], v[92:95]
    s_waitcnt lgkmcnt(4)
    v_mfma_f32_16x16x32_bf16 v[40:43], v[32:35], v[168:171], v[40:43]
    v_mfma_f32_16x16x32_bf16 v[44:47], v[32:35], v[172:175], v[44:47]
    s_barrier
    ds_read_b128 v[144:147], v250 offset:8192
    ds_read_b128 v[148:151], v250 offset:12288
    s_waitcnt lgkmcnt(5)
    v_mfma_f32_16x16x32_bf16 v[64:67], v[152:155], v[168:171], v[64:67]
    ds_read_b128 v[128:131], v248 offset:49152
    v_mfma_f32_16x16x32_bf16 v[80:83], v[152:155], v[172:175], v[80:83]
    s_waitcnt lgkmcnt(5)
    v_mfma_f32_16x16x32_bf16 v[68:71], v[156:159], v[168:171], v[68:71]
    ds_read_b128 v[132:135], v248 offset:51200
    v_mfma_f32_16x16x32_bf16 v[84:87], v[156:159], v[172:175], v[84:87]
    s_waitcnt lgkmcnt(5)
    v_mfma_f32_16x16x32_bf16 v[72:75], v[160:163], v[168:171], v[72:75]
    ds_read_b128 v[136:139], v248 offset:53248
    v_mfma_f32_16x16x32_bf16 v[88:91], v[160:163], v[172:175], v[88:91]
    s_waitcnt lgkmcnt(5)
    v_mfma_f32_16x16x32_bf16 v[76:79], v[164:167], v[168:171], v[76:79]
    ds_read_b128 v[140:143], v248 offset:55296
    v_mfma_f32_16x16x32_bf16 v[92:95], v[164:167], v[172:175], v[92:95]
    s_waitcnt lgkmcnt(4)
    v_mfma_f32_16x16x32_bf16 v[40:43], v[32:35], v[144:147], v[40:43]
    ds_read_b128 v[168:171], v251 offset:8192
    v_mfma_f32_16x16x32_bf16 v[44:47], v[32:35], v[148:151], v[44:47]
    ds_read_b128 v[172:175], v251 offset:12288
    s_waitcnt lgkmcnt(5)
    v_mfma_f32_16x16x32_bf16 v[64:67], v[128:131], v[144:147], v[64:67]
    ds_read_b128 v[152:155], v249 offset:49152
    v_mfma_f32_16x16x32_bf16 v[80:83], v[128:131], v[148:151], v[80:83]
    s_waitcnt lgkmcnt(5)
    v_mfma_f32_16x16x32_bf16 v[68:71], v[132:135], v[144:147], v[68:71]
    ds_read_b128 v[156:159], v249 offset:51200
    v_mfma_f32_16x16x32_bf16 v[84:87], v[132:135], v[148:151], v[84:87]
    s_waitcnt lgkmcnt(5)
    v_mfma_f32_16x16x32_bf16 v[72:75], v[136:139], v[144:147], v[72:75]
    ds_read_b128 v[160:163], v249 offset:53248
    v_mfma_f32_16x16x32_bf16 v[88:91], v[136:139], v[148:151], v[88:91]
    s_waitcnt lgkmcnt(5)
    v_mfma_f32_16x16x32_bf16 v[76:79], v[140:143], v[144:147], v[76:79]
    ds_read_b128 v[164:167], v249 offset:55296
    v_mfma_f32_16x16x32_bf16 v[92:95], v[140:143], v[148:151], v[92:95]
    s_waitcnt lgkmcnt(4)
    v_mfma_f32_16x16x32_bf16 v[40:43], v[32:35], v[168:171], v[40:43]
    ds_read_b128 v[176:179], v252 offset:0
    v_mfma_f32_16x16x32_bf16 v[44:47], v[32:35], v[172:175], v[44:47]
    ds_read_b128 v[192:195], v252 offset:512
    s_waitcnt lgkmcnt(5)
    v_mfma_f32_16x16x32_bf16 v[64:67], v[152:155], v[168:171], v[64:67]
    ds_read_b128 v[180:183], v252 offset:16
    v_mfma_f32_16x16x32_bf16 v[80:83], v[152:155], v[172:175], v[80:83]
    ds_read_b128 v[196:199], v252 offset:528
    s_waitcnt lgkmcnt(6)
    v_mfma_f32_16x16x32_bf16 v[68:71], v[156:159], v[168:171], v[68:71]
    ds_read_b128 v[184:187], v252 offset:32
    v_mfma_f32_16x16x32_bf16 v[84:87], v[156:159], v[172:175], v[84:87]
    ds_read_b128 v[200:203], v252 offset:544
    s_waitcnt lgkmcnt(7)
    v_mfma_f32_16x16x32_bf16 v[72:75], v[160:163], v[168:171], v[72:75]
    ds_read_b128 v[188:191], v252 offset:48
    v_mfma_f32_16x16x32_bf16 v[88:91], v[160:163], v[172:175], v[88:91]
    ds_read_b128 v[204:207], v252 offset:560
    s_waitcnt lgkmcnt(8)
    v_mfma_f32_16x16x32_bf16 v[76:79], v[164:167], v[168:171], v[76:79]
    v_mfma_f32_16x16x32_bf16 v[92:95], v[164:167], v[172:175], v[92:95]
    s_waitcnt lgkmcnt(0)
    s_nop 1
    .p2align 3
    v_pk_fma_f32 v[48:49], v[176:177], v[40:41], v[64:65] neg_lo:[1,0,0] neg_hi:[1,0,0]
    v_pk_fma_f32 v[50:51], v[176:177], v[44:45], v[80:81] neg_lo:[1,0,0] neg_hi:[1,0,0]
    v_pk_mul_f32 v[48:49], v[48:49], v[192:193]
    v_pk_mul_f32 v[50:51], v[50:51], v[192:193]
    v_pk_mul_f32 v[64:65], v[48:49], v[16:17] op_sel_hi:[0,1] neg_hi:[0,1]
    v_pk_mul_f32 v[80:81], v[48:49], v[16:17] op_sel:[1,0] op_sel_hi:[1,1] neg_hi:[0,1]
    v_pk_fma_f32 v[64:65], v[50:51], v[16:17], v[64:65] op_sel:[0,1,0] op_sel_hi:[0,0,1] neg_lo:[0,1,0] neg_hi:[0,1,0]
    v_pk_fma_f32 v[80:81], v[50:51], v[16:17], v[80:81] op_sel:[1,1,0] op_sel_hi:[1,0,1] neg_lo:[0,1,0] neg_hi:[0,1,0]
    v_pk_fma_f32 v[52:53], v[64:65], v[18:19], v[80:81] op_sel_hi:[0,1,1]
    v_pk_fma_f32 v[52:53], v[64:65], v[18:19], v[52:53] op_sel:[1,1,0] op_sel_hi:[1,0,1] neg_lo:[0,1,0]
    v_pk_fma_f32 v[48:49], v[178:179], v[40:41], v[66:67] neg_lo:[1,0,0] neg_hi:[1,0,0]
    v_pk_fma_f32 v[50:51], v[178:179], v[44:45], v[82:83] neg_lo:[1,0,0] neg_hi:[1,0,0]
    v_pk_mul_f32 v[48:49], v[48:49], v[194:195]
    v_pk_mul_f32 v[50:51], v[50:51], v[194:195]
    v_pk_mul_f32 v[66:67], v[48:49], v[16:17] op_sel_hi:[0,1] neg_hi:[0,1]
    v_pk_mul_f32 v[82:83], v[48:49], v[16:17] op_sel:[1,0] op_sel_hi:[1,1] neg_hi:[0,1]
    v_pk_fma_f32 v[66:67], v[50:51], v[16:17], v[66:67] op_sel:[0,1,0] op_sel_hi:[0,0,1] neg_lo:[0,1,0] neg_hi:[0,1,0]
    v_pk_fma_f32 v[82:83], v[50:51], v[16:17], v[82:83] op_sel:[1,1,0] op_sel_hi:[1,0,1] neg_lo:[0,1,0] neg_hi:[0,1,0]
    v_pk_fma_f32 v[54:55], v[52:53], v[18:19], v[66:67] op_sel_hi:[0,1,1]
    v_pk_fma_f32 v[54:55], v[52:53], v[18:19], v[54:55] op_sel:[1,1,0] op_sel_hi:[1,0,1] neg_lo:[0,1,0]
    v_pk_fma_f32 v[52:53], v[54:55], v[18:19], v[82:83] op_sel_hi:[0,1,1]
    v_pk_fma_f32 v[52:53], v[54:55], v[18:19], v[52:53] op_sel:[1,1,0] op_sel_hi:[1,0,1] neg_lo:[0,1,0]
    v_pk_fma_f32 v[48:49], v[180:181], v[40:41], v[68:69] neg_lo:[1,0,0] neg_hi:[1,0,0]
    v_pk_fma_f32 v[50:51], v[180:181], v[44:45], v[84:85] neg_lo:[1,0,0] neg_hi:[1,0,0]
    v_pk_mul_f32 v[48:49], v[48:49], v[196:197]
    v_pk_mul_f32 v[50:51], v[50:51], v[196:197]
    v_pk_mul_f32 v[68:69], v[48:49], v[16:17] op_sel_hi:[0,1] neg_hi:[0,1]
    v_pk_mul_f32 v[84:85], v[48:49], v[16:17] op_sel:[1,0] op_sel_hi:[1,1] neg_hi:[0,1]
    v_pk_fma_f32 v[68:69], v[50:51], v[16:17], v[68:69] op_sel:[0,1,0] op_sel_hi:[0,0,1] neg_lo:[0,1,0] neg_hi:[0,1,0]
    v_pk_fma_f32 v[84:85], v[50:51], v[16:17], v[84:85] op_sel:[1,1,0] op_sel_hi:[1,0,1] neg_lo:[0,1,0] neg_hi:[0,1,0]
    v_pk_fma_f32 v[54:55], v[52:53], v[18:19], v[68:69] op_sel_hi:[0,1,1]
    v_pk_fma_f32 v[54:55], v[52:53], v[18:19], v[54:55] op_sel:[1,1,0] op_sel_hi:[1,0,1] neg_lo:[0,1,0]
    v_pk_fma_f32 v[52:53], v[54:55], v[18:19], v[84:85] op_sel_hi:[0,1,1]
    v_pk_fma_f32 v[52:53], v[54:55], v[18:19], v[52:53] op_sel:[1,1,0] op_sel_hi:[1,0,1] neg_lo:[0,1,0]
    v_pk_fma_f32 v[48:49], v[182:183], v[40:41], v[70:71] neg_lo:[1,0,0] neg_hi:[1,0,0]
    v_pk_fma_f32 v[50:51], v[182:183], v[44:45], v[86:87] neg_lo:[1,0,0] neg_hi:[1,0,0]
    v_pk_mul_f32 v[48:49], v[48:49], v[198:199]
    v_pk_mul_f32 v[50:51], v[50:51], v[198:199]
    v_pk_mul_f32 v[70:71], v[48:49], v[16:17] op_sel_hi:[0,1] neg_hi:[0,1]
    v_pk_mul_f32 v[86:87], v[48:49], v[16:17] op_sel:[1,0] op_sel_hi:[1,1] neg_hi:[0,1]
    v_pk_fma_f32 v[70:71], v[50:51], v[16:17], v[70:71] op_sel:[0,1,0] op_sel_hi:[0,0,1] neg_lo:[0,1,0] neg_hi:[0,1,0]
    v_pk_fma_f32 v[86:87], v[50:51], v[16:17], v[86:87] op_sel:[1,1,0] op_sel_hi:[1,0,1] neg_lo:[0,1,0] neg_hi:[0,1,0]
    v_pk_fma_f32 v[54:55], v[52:53], v[18:19], v[70:71] op_sel_hi:[0,1,1]
    v_pk_fma_f32 v[54:55], v[52:53], v[18:19], v[54:55] op_sel:[1,1,0] op_sel_hi:[1,0,1] neg_lo:[0,1,0]
    v_pk_fma_f32 v[52:53], v[54:55], v[18:19], v[86:87] op_sel_hi:[0,1,1]
    v_pk_fma_f32 v[52:53], v[54:55], v[18:19], v[52:53] op_sel:[1,1,0] op_sel_hi:[1,0,1] neg_lo:[0,1,0]
    v_pk_fma_f32 v[48:49], v[184:185], v[40:41], v[72:73] neg_lo:[1,0,0] neg_hi:[1,0,0]
    v_pk_fma_f32 v[50:51], v[184:185], v[44:45], v[88:89] neg_lo:[1,0,0] neg_hi:[1,0,0]
    v_pk_mul_f32 v[48:49], v[48:49], v[200:201]
    v_pk_mul_f32 v[50:51], v[50:51], v[200:201]
    v_pk_mul_f32 v[72:73], v[48:49], v[16:17] op_sel_hi:[0,1] neg_hi:[0,1]
    v_pk_mul_f32 v[88:89], v[48:49], v[16:17] op_sel:[1,0] op_sel_hi:[1,1] neg_hi:[0,1]
    v_pk_fma_f32 v[72:73], v[50:51], v[16:17], v[72:73] op_sel:[0,1,0] op_sel_hi:[0,0,1] neg_lo:[0,1,0] neg_hi:[0,1,0]
    v_pk_fma_f32 v[88:89], v[50:51], v[16:17], v[88:89] op_sel:[1,1,0] op_sel_hi:[1,0,1] neg_lo:[0,1,0] neg_hi:[0,1,0]
    v_pk_fma_f32 v[54:55], v[52:53], v[18:19], v[72:73] op_sel_hi:[0,1,1]
    v_pk_fma_f32 v[54:55], v[52:53], v[18:19], v[54:55] op_sel:[1,1,0] op_sel_hi:[1,0,1] neg_lo:[0,1,0]
    v_pk_fma_f32 v[52:53], v[54:55], v[18:19], v[88:89] op_sel_hi:[0,1,1]
    v_pk_fma_f32 v[52:53], v[54:55], v[18:19], v[52:53] op_sel:[1,1,0] op_sel_hi:[1,0,1] neg_lo:[0,1,0]
    v_pk_fma_f32 v[48:49], v[186:187], v[40:41], v[74:75] neg_lo:[1,0,0] neg_hi:[1,0,0]
    v_pk_fma_f32 v[50:51], v[186:187], v[44:45], v[90:91] neg_lo:[1,0,0] neg_hi:[1,0,0]
    v_pk_mul_f32 v[48:49], v[48:49], v[202:203]
    v_pk_mul_f32 v[50:51], v[50:51], v[202:203]
    v_pk_mul_f32 v[74:75], v[48:49], v[16:17] op_sel_hi:[0,1] neg_hi:[0,1]
    v_pk_mul_f32 v[90:91], v[48:49], v[16:17] op_sel:[1,0] op_sel_hi:[1,1] neg_hi:[0,1]
    v_pk_fma_f32 v[74:75], v[50:51], v[16:17], v[74:75] op_sel:[0,1,0] op_sel_hi:[0,0,1] neg_lo:[0,1,0] neg_hi:[0,1,0]
    v_pk_fma_f32 v[90:91], v[50:51], v[16:17], v[90:91] op_sel:[1,1,0] op_sel_hi:[1,0,1] neg_lo:[0,1,0] neg_hi:[0,1,0]
    v_pk_fma_f32 v[54:55], v[52:53], v[18:19], v[74:75] op_sel_hi:[0,1,1]
    v_pk_fma_f32 v[54:55], v[52:53], v[18:19], v[54:55] op_sel:[1,1,0] op_sel_hi:[1,0,1] neg_lo:[0,1,0]
    v_pk_fma_f32 v[52:53], v[54:55], v[18:19], v[90:91] op_sel_hi:[0,1,1]
    v_pk_fma_f32 v[52:53], v[54:55], v[18:19], v[52:53] op_sel:[1,1,0] op_sel_hi:[1,0,1] neg_lo:[0,1,0]
    v_pk_fma_f32 v[48:49], v[188:189], v[40:41], v[76:77] neg_lo:[1,0,0] neg_hi:[1,0,0]
    v_pk_fma_f32 v[50:51], v[188:189], v[44:45], v[92:93] neg_lo:[1,0,0] neg_hi:[1,0,0]
    v_pk_mul_f32 v[48:49], v[48:49], v[204:205]
    v_pk_mul_f32 v[50:51], v[50:51], v[204:205]
    v_pk_mul_f32 v[76:77], v[48:49], v[16:17] op_sel_hi:[0,1] neg_hi:[0,1]
    v_pk_mul_f32 v[92:93], v[48:49], v[16:17] op_sel:[1,0] op_sel_hi:[1,1] neg_hi:[0,1]
    v_pk_fma_f32 v[76:77], v[50:51], v[16:17], v[76:77] op_sel:[0,1,0] op_sel_hi:[0,0,1] neg_lo:[0,1,0] neg_hi:[0,1,0]
    v_pk_fma_f32 v[92:93], v[50:51], v[16:17], v[92:93] op_sel:[1,1,0] op_sel_hi:[1,0,1] neg_lo:[0,1,0] neg_hi:[0,1,0]
    v_pk_fma_f32 v[54:55], v[52:53], v[18:19], v[76:77] op_sel_hi:[0,1,1]
    v_pk_fma_f32 v[54:55], v[52:53], v[18:19], v[54:55] op_sel:[1,1,0] op_sel_hi:[1,0,1] neg_lo:[0,1,0]
    v_pk_fma_f32 v[52:53], v[54:55], v[18:19], v[92:93] op_sel_hi:[0,1,1]
    v_pk_fma_f32 v[52:53], v[54:55], v[18:19], v[52:53] op_sel:[1,1,0] op_sel_hi:[1,0,1] neg_lo:[0,1,0]
    v_pk_fma_f32 v[48:49], v[190:191], v[40:41], v[78:79] neg_lo:[1,0,0] neg_hi:[1,0,0]
    v_pk_fma_f32 v[50:51], v[190:191], v[44:45], v[94:95] neg_lo:[1,0,0] neg_hi:[1,0,0]
    v_pk_mul_f32 v[48:49], v[48:49], v[206:207]
    v_pk_mul_f32 v[50:51], v[50:51], v[206:207]
    v_pk_mul_f32 v[78:79], v[48:49], v[16:17] op_sel_hi:[0,1] neg_hi:[0,1]
    v_pk_mul_f32 v[94:95], v[48:49], v[16:17] op_sel:[1,0] op_sel_hi:[1,1] neg_hi:[0,1]
    v_pk_fma_f32 v[78:79], v[50:51], v[16:17], v[78:79] op_sel:[0,1,0] op_sel_hi:[0,0,1] neg_lo:[0,1,0] neg_hi:[0,1,0]
    v_pk_fma_f32 v[94:95], v[50:51], v[16:17], v[94:95] op_sel:[1,1,0] op_sel_hi:[1,0,1] neg_lo:[0,1,0] neg_hi:[0,1,0]
    v_pk_fma_f32 v[54:55], v[52:53], v[18:19], v[78:79] op_sel_hi:[0,1,1]
    v_pk_fma_f32 v[54:55], v[52:53], v[18:19], v[54:55] op_sel:[1,1,0] op_sel_hi:[1,0,1] neg_lo:[0,1,0]
    v_pk_fma_f32 v[52:53], v[54:55], v[18:19], v[94:95] op_sel_hi:[0,1,1]
    v_pk_fma_f32 v[52:53], v[54:55], v[18:19], v[52:53] op_sel:[1,1,0] op_sel_hi:[1,0,1] neg_lo:[0,1,0]
    v_mov_b32 v54, v52
    v_mov_b32 v55, v53
    s_nop 1
    v_permlane16_swap_b32 v52, v54
    v_permlane16_swap_b32 v53, v55
    v_mov_b32 v48, v52
    v_mov_b32 v49, v53
    v_mov_b32 v50, v54
    v_mov_b32 v51, v55
    v_permlane32_swap_b32 v52, v48
    v_permlane32_swap_b32 v53, v49
    v_permlane32_swap_b32 v54, v50
    v_permlane32_swap_b32 v55, v51
    s_nop 0
    v_pk_fma_f32 v[54:55], v[52:53], v[20:21], v[54:55] op_sel_hi:[0,1,1]
    v_pk_fma_f32 v[54:55], v[52:53], v[20:21], v[54:55] op_sel:[1,1,0] op_sel_hi:[1,0,1] neg_lo:[0,1,0]
    v_pk_fma_f32 v[48:49], v[54:55], v[20:21], v[48:49] op_sel_hi:[0,1,1]
    v_pk_fma_f32 v[48:49], v[54:55], v[20:21], v[48:49] op_sel:[1,1,0] op_sel_hi:[1,0,1] neg_lo:[0,1,0]
    v_pk_fma_f32 v[56:57], v[48:49], v[20:21], v[50:51] op_sel_hi:[0,1,1]
    v_pk_fma_f32 v[56:57], v[48:49], v[20:21], v[56:57] op_sel:[1,1,0] op_sel_hi:[1,0,1] neg_lo:[0,1,0]
    ds_write_b64 v122, v[56:57]
    v_cndmask_b32 v52, 0, v52, s[42:43]
    v_cndmask_b32 v54, v54, v48, s[42:43]
    v_cndmask_b32 v28, v52, v54, s[44:45]
    v_cndmask_b32 v53, 0, v53, s[42:43]
    v_cndmask_b32 v55, v55, v49, s[42:43]
    v_cndmask_b32 v29, v53, v55, s[44:45]
    s_waitcnt lgkmcnt(0)
    s_barrier
    ds_read_b64 v[48:49], v123
    s_waitcnt lgkmcnt(0)
    v_mul_f32 v48, s59, v48
    v_mul_f32 v49, s59, v49
    v_mul_f32 v56, s59, v56
    v_mul_f32 v57, s59, v57
    v_fmac_f32 v56, v48, v30
    v_fmac_f32 v57, v48, v31
    v_fma_f32 v56, -v49, v31, v56
    v_fmac_f32 v57, v49, v30
    s_mov_b64 exec, 0xffff
    buffer_store_dwordx4 v[56:59], v124, s[16:19], s75 offen sc1
    s_mov_b64 exec, -1
    v_fmac_f32 v28, v48, v22
    v_fmac_f32 v29, v48, v23
    v_fma_f32 v28, -v49, v23, v28
    v_fmac_f32 v29, v49, v22
    s_add_u32 m0, s85, 65536
    s_mov_b32 s4, s46
    s_mov_b32 s5, s47
    s_xor_b32 s69, s68, 0
    buffer_load_dwordx4 v10, s[4:7], s69 offen lds
    v_lshrrev_b32 v2, 4, v0
    v_and_b32 v3, 7, v0
    buffer_load_dwordx4 v11, s[4:7], s69 offen offset:1024 lds
    v_lshlrev_b32 v2, 1, v2
    v_xor_b32 v2, v2, v3
    buffer_load_dwordx4 v12, s[4:7], s69 offen offset:2048 lds
    v_lshlrev_b32 v2, 4, v2
    v_lshrrev_b32 v3, 3, v0
    buffer_load_dwordx4 v13, s[4:7], s69 offen offset:3072 lds
    v_lshl_add_u32 v32, v3, 10, v2
    v_add_u32 v33, 7168, v32
    v_add_u32 v34, 14336, v32
    v_add_u32 v35, 21504, v32
    s_barrier
    s_add_u32 s20, s30, 3
    s_and_b32 s20, s20, 7
    s_mul_i32 s20, s20, 229376
    s_add_u32 m0, s90, 57344
    s_add_u32 s70, s73, s20
    buffer_load_dwordx4 v8, s[12:15], s70 offen lds
    s_mul_i32 s20, s31, 12
    s_add_u32 s20, s20, s33
    s_lshl_b32 s20, s20, 7
    s_add_u32 s20, s20, 1048576
    s_add_u32 s42, s66, s20
    s_addc_u32 s43, s67, 0
    v_readfirstlane_b32 s40, v1
    v_readfirstlane_b32 s41, v1
    buffer_load_dwordx4 v9, s[12:15], s70 offen offset:1024 lds
    s_add_u32 m0, s90, 8192
    s_add_u32 s70, s70, 114688
    buffer_load_dwordx4 v8, s[12:15], s70 offen lds
    buffer_load_dwordx4 v9, s[12:15], s70 offen offset:1024 lds
    s_add_u32 m0, s85, 69632
    s_add_u32 s69, s69, 32768
    buffer_load_dwordx4 v10, s[4:7], s69 offen lds
    s_barrier
    s_add_u32 s20, s30, 4
    s_and_b32 s20, s20, 7
    s_mul_i32 s20, s20, 229376
    s_add_u32 m0, s90, 16384
    s_add_u32 s70, s73, s20
    buffer_load_dwordx4 v8, s[12:15], s70 offen lds
    buffer_load_dwordx4 v9, s[12:15], s70 offen offset:1024 lds
    s_add_u32 m0, s90, 24576
    s_add_u32 s70, s70, 114688
    buffer_load_dwordx4 v8, s[12:15], s70 offen lds
    buffer_load_dwordx4 v9, s[12:15], s70 offen offset:1024 lds
    s_add_u32 m0, s85, 69632
    s_nop 0
    buffer_load_dwordx4 v11, s[4:7], s69 offen offset:1024 lds
    buffer_load_dwordx4 v12, s[4:7], s69 offen offset:2048 lds
    buffer_load_dwordx4 v13, s[4:7], s69 offen offset:3072 lds
    s_add_u32 m0, s85, 98304
    s_lshl_b32 s69, s78, 16
    s_add_u32 s69, s69, s72
    buffer_load_dwordx4 v32, s[8:11], s69 offen lds
    s_waitcnt vmcnt(9)
    s_barrier
    s_add_u32 s20, s30, 5
    s_and_b32 s20, s20, 7
    s_mul_i32 s20, s20, 229376
    s_add_u32 m0, s90, 32768
    s_add_u32 s70, s73, s20
    buffer_load_dwordx4 v8, s[12:15], s70 offen lds
    buffer_load_dwordx4 v9, s[12:15], s70 offen offset:1024 lds
    s_add_u32 m0, s90, 40960
    s_add_u32 s70, s70, 114688
    buffer_load_dwordx4 v8, s[12:15], s70 offen lds
    buffer_load_dwordx4 v9, s[12:15], s70 offen offset:1024 lds
    buffer_load_dwordx4 v[108:111], v121, s[16:19], s75 offen sc1
    buffer_load_dwordx4 v[104:107], v120, s[16:19], s75 offen sc1
    buffer_load_dwordx4 v[100:103], v119, s[16:19], s75 offen sc1
    buffer_load_dwordx4 v[96:99], v118, s[16:19], s75 offen sc1
    s_add_u32 m0, s85, 98304
    s_nop 0
    buffer_load_dwordx4 v33, s[8:11], s69 offen offset:1024 lds
    buffer_load_dwordx4 v34, s[8:11], s69 offen offset:2048 lds
    buffer_load_dwordx4 v35, s[8:11], s69 offen offset:3072 lds
    s_waitcnt vmcnt(15)
    s_barrier
    s_add_u32 s20, s30, 6
    s_and_b32 s20, s20, 7
    s_mul_i32 s20, s20, 229376
    s_add_u32 m0, s90, 49152
    s_add_u32 s70, s73, s20
    buffer_load_dwordx4 v8, s[12:15], s70 offen lds
    s_waitcnt vmcnt(13)
    ds_read_b64 v[128:129], v60 offset:0
    buffer_load_dwordx4 v9, s[12:15], s70 offen offset:1024 lds
    ds_read_b64 v[132:133], v60 offset:2048
    ds_read_b64 v[136:137], v60 offset:4096
    s_add_u32 m0, s90, 57344
    s_add_u32 s70, s70, 114688
    buffer_load_dwordx4 v8, s[12:15], s70 offen lds
    ds_read_b64 v[140:141], v60 offset:6144
    ds_read_b64 v[144:145], v61 offset:0
    buffer_load_dwordx4 v9, s[12:15], s70 offen offset:1024 lds
    ds_read_b64 v[148:149], v61 offset:2048
    ds_read_b64 v[152:153], v61 offset:4096
    s_add_u32 m0, s85, 102400
    s_add_u32 s69, s69, 32768
    buffer_load_dwordx4 v32, s[8:11], s69 offen lds
    ds_read_b64 v[156:157], v61 offset:6144
    ds_read_b64 v[160:161], v62 offset:0
    s_waitcnt vmcnt(8)
L_chk_1:
    v_xor_b32 v5, v110, v1
    v_bitop3_b32 v5, v106, v1, v5 bitop3:0xbe
    v_bitop3_b32 v5, v102, v1, v5 bitop3:0xbe
    v_bitop3_b32 v5, v98, v1, v5 bitop3:0xbe
    v_cmp_ne_u32 vcc, 0, v5
    s_nop 4
    s_cbranch_vccnz L_retry_3
L_ok_2:
    v_fmac_f32 v104, v108, v26
    v_fmac_f32 v105, v108, v27
    v_fmac_f32 v104, v109, v39
    buffer_load_dwordx4 v33, s[8:11], s69 offen offset:1024 lds
    ds_read_b64 v[164:165], v62 offset:2048
    ds_read_b64 v[168:169], v62 offset:4096
    v_fmac_f32 v105, v109, v26
    v_fmac_f32 v100, v104, v26
    v_fmac_f32 v101, v104, v27
    v_fmac_f32 v100, v105, v39
    buffer_load_dwordx4 v34, s[8:11], s69 offen offset:2048 lds
    ds_read_b64 v[172:173], v62 offset:6144
    ds_read_b64 v[176:177], v63 offset:0
    v_fmac_f32 v101, v105, v26
    v_fmac_f32 v96, v100, v26
    v_fmac_f32 v97, v100, v27
    v_fmac_f32 v96, v101, v39
    buffer_load_dwordx4 v35, s[8:11], s69 offen offset:3072 lds
    ds_read_b64 v[180:181], v63 offset:2048
    ds_read_b64 v[184:185], v63 offset:4096
    v_fmac_f32 v97, v101, v26
    v_mul_f32 v48, v96, v24
    v_mul_f32 v49, v96, v25
    v_fma_f32 v48, -v97, v25, v48
    s_add_u32 m0, s85, 131072
    s_lshl_b32 s69, s79, 16
    s_add_u32 s69, s69, s72
    buffer_load_dwordx4 v32, s[8:11], s69 offen lds
    ds_read_b64 v[188:189], v63 offset:6144
    v_fmac_f32 v49, v97, v24
    v_mov_b32 v50, v48
    v_mov_b32 v51, v49
    s_nop 1
    v_permlane16_swap_b32 v48, v50
    v_permlane16_swap_b32 v49, v51
    s_nop 1
    v_add_f32 v48, v48, v50
    v_add_f32 v49, v49, v51
    s_waitcnt lgkmcnt(0)
    s_barrier
    s_add_u32 s20, s30, 7
    s_and_b32 s20, s20, 7
    s_mul_i32 s20, s20, 229376
    s_add_u32 m0, s90, 8192
    s_add_u32 s70, s73, s20
    buffer_load_dwordx4 v8, s[12:15], s70 offen lds
    v_mov_b32 v50, v48
    v_mov_b32 v51, v49
    s_nop 1
    v_permlane32_swap_b32 v48, v50
    v_permlane32_swap_b32 v49, v51
    s_nop 1
    v_add_f32 v48, v48, v50
    v_add_f32 v49, v49, v51
    buffer_load_dwordx4 v9, s[12:15], s70 offen offset:1024 lds
    v_fmac_f32 v28, v48, v126
    v_fmac_f32 v29, v48, v127
    v_fma_f32 v28, -v49, v127, v28
    v_fmac_f32 v29, v49, v126
    v_fmac_f32 v64, v28, v18
    s_add_u32 m0, s90, 16384
    s_add_u32 s70, s70, 114688
    buffer_load_dwordx4 v8, s[12:15], s70 offen lds
    v_fmac_f32 v65, v28, v19
    v_fmac_f32 v64, v29, v38
    v_fmac_f32 v65, v29, v18
    v_fmac_f32 v80, v64, v18
    buffer_load_dwordx4 v9, s[12:15], s70 offen offset:1024 lds
    v_fmac_f32 v81, v64, v19
    v_fmac_f32 v80, v65, v38
    v_fmac_f32 v81, v65, v18
    v_cvt_pk_bf16_f32 v112, v64, v80
    s_add_u32 m0, s85, 131072
    s_nop 0
    buffer_load_dwordx4 v33, s[8:11], s69 offen offset:1024 lds
    v_cvt_pk_bf16_f32 v114, v65, v81
    v_fmac_f32 v66, v80, v18
    v_fmac_f32 v67, v80, v19
    v_fmac_f32 v66, v81, v38
    buffer_load_dwordx4 v34, s[8:11], s69 offen offset:2048 lds
    v_fmac_f32 v67, v81, v18
    v_fmac_f32 v82, v66, v18
    v_fmac_f32 v83, v66, v19
    v_fmac_f32 v82, v67, v38
    buffer_load_dwordx4 v35, s[8:11], s69 offen offset:3072 lds
    v_fmac_f32 v83, v67, v18
    v_cvt_pk_bf16_f32 v113, v66, v82
    v_cvt_pk_bf16_f32 v115, v67, v83
    v_fmac_f32 v68, v82, v18
    s_add_u32 m0, s85, 135168
    s_add_u32 s69, s69, 32768
    buffer_load_dwordx4 v32, s[8:11], s69 offen lds
    v_fmac_f32 v69, v82, v19
    v_fmac_f32 v68, v83, v38
    v_fmac_f32 v69, v83, v18
    v_fmac_f32 v84, v68, v18
    buffer_load_dwordx4 v33, s[8:11], s69 offen offset:1024 lds
    v_fmac_f32 v85, v68, v19
    v_fmac_f32 v84, v69, v38
    v_fmac_f32 v85, v69, v18
    v_cvt_pk_bf16_f32 v116, v68, v84
    v_cvt_pk_bf16_f32 v118, v69, v85
    v_fmac_f32 v70, v84, v18
    v_fmac_f32 v71, v84, v19
    v_fmac_f32 v70, v85, v38
    s_waitcnt vmcnt(14)
    s_barrier
    s_add_u32 m0, s85, 135168
    s_nop 0
    buffer_load_dwordx4 v34, s[8:11], s69 offen offset:2048 lds
    v_fmac_f32 v71, v85, v18
    v_fmac_f32 v86, v70, v18
    v_fmac_f32 v87, v70, v19
    v_fmac_f32 v86, v71, v38
    v_fmac_f32 v87, v71, v18
    v_cvt_pk_bf16_f32 v117, v70, v86
    buffer_load_dwordx4 v35, s[8:11], s69 offen offset:3072 lds
    v_cvt_pk_bf16_f32 v119, v71, v87
    v_fmac_f32 v72, v86, v18
    v_fmac_f32 v73, v86, v19
    v_fmac_f32 v72, v87, v38
    v_fmac_f32 v73, v87, v18
    v_fmac_f32 v88, v72, v18
    s_add_u32 m0, s85, 65536
    s_mov_b32 s4, s48
    s_mov_b32 s5, s49
    s_xor_b32 s69, s68, 0
    buffer_load_dwordx4 v10, s[4:7], s69 offen lds
    v_fmac_f32 v89, v72, v19
    v_fmac_f32 v88, v73, v38
    v_fmac_f32 v89, v73, v18
    v_cvt_pk_bf16_f32 v120, v72, v88
    v_cvt_pk_bf16_f32 v122, v73, v89
    v_fmac_f32 v74, v88, v18
    buffer_load_dwordx4 v11, s[4:7], s69 offen offset:1024 lds
    v_fmac_f32 v75, v88, v19
    v_fmac_f32 v74, v89, v38
    v_fmac_f32 v75, v89, v18
    v_fmac_f32 v90, v74, v18
    v_fmac_f32 v91, v74, v19
    v_fmac_f32 v90, v75, v38
    buffer_load_dwordx4 v12, s[4:7], s69 offen offset:2048 lds
    v_fmac_f32 v91, v75, v18
    v_cvt_pk_bf16_f32 v121, v74, v90
    v_cvt_pk_bf16_f32 v123, v75, v91
    v_fmac_f32 v76, v90, v18
    v_fmac_f32 v77, v90, v19
    v_fmac_f32 v76, v91, v38
    buffer_load_dwordx4 v13, s[4:7], s69 offen offset:3072 lds
    v_fmac_f32 v77, v91, v18
    v_fmac_f32 v92, v76, v18
    v_fmac_f32 v93, v76, v19
    v_fmac_f32 v92, v77, v38
    v_fmac_f32 v93, v77, v18
    v_cvt_pk_bf16_f32 v124, v76, v92
    s_add_u32 m0, s85, 69632
    s_add_u32 s69, s69, 32768
    buffer_load_dwordx4 v10, s[4:7], s69 offen lds
    v_cvt_pk_bf16_f32 v126, v77, v93
    v_fmac_f32 v78, v92, v18
    v_fmac_f32 v79, v92, v19
    v_fmac_f32 v78, v93, v38
    v_fmac_f32 v79, v93, v18
    v_fmac_f32 v94, v78, v18
    v_fmac_f32 v95, v78, v19
    v_fmac_f32 v94, v79, v38
    s_waitcnt vmcnt(12)
    s_barrier
    s_add_u32 m0, s85, 69632
    s_nop 0
    buffer_load_dwordx4 v11, s[4:7], s69 offen offset:1024 lds
    v_fmac_f32 v95, v79, v18
    v_cvt_pk_bf16_f32 v125, v78, v94
    v_cvt_pk_bf16_f32 v127, v79, v95
    s_mul_i32 s22, s88, 88
    s_add_u32 s22, s22, s74
    v_mfma_f32_16x16x16_bf16 v[64:67], v[112:113], v[36:37], 0
    v_mfma_f32_16x16x16_bf16 v[68:71], v[114:115], v[36:37], 0
    v_mfma_f32_16x16x16_bf16 v[72:75], v[116:117], v[36:37], 0
    v_mfma_f32_16x16x16_bf16 v[76:79], v[118:119], v[36:37], 0
    v_mfma_f32_16x16x16_bf16 v[80:83], v[120:121], v[36:37], 0
    v_mfma_f32_16x16x16_bf16 v[84:87], v[122:123], v[36:37], 0
    v_mfma_f32_16x16x16_bf16 v[88:91], v[124:125], v[36:37], 0
    v_mfma_f32_16x16x16_bf16 v[92:95], v[126:127], v[36:37], 0
    s_lshl_b32 s71, s22, 12
    s_add_u32 s71, s71, 2097152
    s_mul_i32 s22, s88, 12
    s_lshr_b32 s23, s74, 3
    s_add_u32 s22, s22, s23
    s_lshl_b32 s22, s22, 7
    s_and_b32 s74, s74, 7
    s_lshl2_add_u32 s74, s74, s22
    buffer_load_dwordx4 v12, s[4:7], s69 offen offset:2048 lds
    buffer_load_dwordx4 v13, s[4:7], s69 offen offset:3072 lds
    v_cvt_pk_bf16_f32 v112, v64, v65
    v_cvt_pk_bf16_f32 v113, v66, v67
    v_cvt_pk_bf16_f32 v114, v68, v69
    v_cvt_pk_bf16_f32 v115, v70, v71
    buffer_store_dwordx4 v[112:115], v14, s[16:19], s71 offen sc1
    v_cvt_pk_bf16_f32 v116, v72, v73
    v_cvt_pk_bf16_f32 v117, v74, v75
    v_cvt_pk_bf16_f32 v118, v76, v77
    v_cvt_pk_bf16_f32 v119, v78, v79
    buffer_store_dwordx4 v[116:119], v15, s[16:19], s71 offen sc1
    v_cvt_pk_bf16_f32 v120, v80, v81
    v_cvt_pk_bf16_f32 v121, v82, v83
    v_cvt_pk_bf16_f32 v122, v84, v85
    v_cvt_pk_bf16_f32 v123, v86, v87
    buffer_store_dwordx4 v[120:123], v14, s[16:19], s71 offen offset:2048 sc1
    v_cvt_pk_bf16_f32 v124, v88, v89
    v_cvt_pk_bf16_f32 v125, v90, v91
    v_cvt_pk_bf16_f32 v126, v92, v93
    v_cvt_pk_bf16_f32 v127, v94, v95
    buffer_store_dwordx4 v[124:127], v15, s[16:19], s71 offen offset:2048 sc1
    s_barrier
    s_barrier
    s_add_u32 m0, s85, 0
    s_mov_b32 s4, s46
    s_mov_b32 s5, s47
    s_xor_b32 s69, s68, 128
    buffer_load_dwordx4 v10, s[4:7], s69 offen lds
    buffer_load_dwordx4 v11, s[4:7], s69 offen offset:1024 lds
    buffer_load_dwordx4 v12, s[4:7], s69 offen offset:2048 lds
    buffer_load_dwordx4 v13, s[4:7], s69 offen offset:3072 lds
    s_waitcnt vmcnt(8)
    s_add_u32 m0, s85, 4096
    s_add_u32 s69, s69, 32768
    buffer_load_dwordx4 v10, s[4:7], s69 offen lds
    ds_read_b64 v[130:131], v60 offset:0
    ds_read_b64 v[134:135], v60 offset:2048
    ds_read_b64 v[138:139], v60 offset:4096
    ds_read_b64 v[142:143], v60 offset:6144
    buffer_load_dwordx4 v11, s[4:7], s69 offen offset:1024 lds
    ds_read_b64 v[146:147], v61 offset:0
    ds_read_b64 v[150:151], v61 offset:2048
    ds_read_b64 v[154:155], v61 offset:4096
    ds_read_b64 v[158:159], v61 offset:6144
    buffer_load_dwordx4 v12, s[4:7], s69 offen offset:2048 lds
    ds_read_b64 v[162:163], v62 offset:0
    ds_read_b64 v[166:167], v62 offset:2048
    ds_read_b64 v[170:171], v62 offset:4096
    ds_read_b64 v[174:175], v62 offset:6144
    buffer_load_dwordx4 v13, s[4:7], s69 offen offset:3072 lds
    ds_read_b64 v[178:179], v63 offset:0
    ds_read_b64 v[182:183], v63 offset:2048
    ds_read_b64 v[186:187], v63 offset:4096
    ds_read_b64 v[190:191], v63 offset:6144
    s_add_u32 m0, s85, 32768
    s_mov_b32 s4, s48
    s_mov_b32 s5, s49
    s_xor_b32 s69, s68, 128
    buffer_load_dwordx4 v10, s[4:7], s69 offen lds
    s_waitcnt lgkmcnt(0)
    buffer_load_dwordx4 v11, s[4:7], s69 offen offset:1024 lds
    buffer_load_dwordx4 v12, s[4:7], s69 offen offset:2048 lds
    buffer_load_dwordx4 v13, s[4:7], s69 offen offset:3072 lds
    s_waitcnt vmcnt(12)
    s_add_u32 s20, s74, 1048576
    s_mov_b64 exec, 1
    buffer_store_dword v1, off, s[16:19], s20 sc1
    s_mov_b64 exec, -1
    s_add_u32 m0, s85, 36864
    s_add_u32 s69, s69, 32768
    buffer_load_dwordx4 v10, s[4:7], s69 offen lds
    buffer_load_dwordx4 v11, s[4:7], s69 offen offset:1024 lds
    buffer_load_dwordx4 v12, s[4:7], s69 offen offset:2048 lds
    s_waitcnt vmcnt(8)
    buffer_load_dwordx4 v13, s[4:7], s69 offen offset:3072 lds
    s_setprio 3
    v_subrev_u32 v60, 65536, v60
    v_subrev_u32 v61, 65536, v61
    v_subrev_u32 v62, 65536, v62
    v_subrev_u32 v63, 65536, v63
    s_setprio 0
    ds_read_b64 v[192:193], v60 offset:0
    ds_read_b64 v[196:197], v60 offset:2048
    ds_read_b64 v[200:201], v60 offset:4096
    ds_read_b64 v[204:205], v60 offset:6144
    s_add_u32 m0, s85, 65536
    s_lshl_b32 s69, s80, 16
    s_add_u32 s69, s69, s72
    buffer_load_dwordx4 v32, s[8:11], s69 offen lds
    ds_read_b64 v[208:209], v61 offset:0
    ds_read_b64 v[212:213], v61 offset:2048
    ds_read_b64 v[216:217], v61 offset:4096
    ds_read_b64 v[220:221], v61 offset:6144
    buffer_load_dwordx4 v33, s[8:11], s69 offen offset:1024 lds
    ds_read_b64 v[224:225], v62 offset:0
    ds_read_b64 v[228:229], v62 offset:2048
    ds_read_b64 v[232:233], v62 offset:4096
    ds_read_b64 v[236:237], v62 offset:6144
    buffer_load_dwordx4 v34, s[8:11], s69 offen offset:2048 lds
    ds_read_b64 v[240:241], v63 offset:0
    ds_read_b64 v[244:245], v63 offset:2048
    ds_read_b64 v[248:249], v63 offset:4096
    ds_read_b64 v[252:253], v63 offset:6144
    buffer_load_dwordx4 v35, s[8:11], s69 offen offset:3072 lds
    s_waitcnt lgkmcnt(0)
    s_add_u32 m0, s85, 69632
    s_add_u32 s69, s69, 32768
    buffer_load_dwordx4 v32, s[8:11], s69 offen lds
    buffer_load_dwordx4 v33, s[8:11], s69 offen offset:1024 lds
    buffer_load_dwordx4 v34, s[8:11], s69 offen offset:2048 lds
    buffer_load_dwordx4 v35, s[8:11], s69 offen offset:3072 lds
    s_waitcnt vmcnt(8)
    s_add_u32 m0, s85, 0
    s_lshl_b32 s69, s81, 16
    s_add_u32 s69, s69, s72
    buffer_load_dwordx4 v32, s[8:11], s69 offen lds
    ds_read_b64 v[194:195], v60 offset:32768
    ds_read_b64 v[198:199], v60 offset:34816
    ds_read_b64 v[202:203], v60 offset:36864
    ds_read_b64 v[206:207], v60 offset:38912
    buffer_load_dwordx4 v33, s[8:11], s69 offen offset:1024 lds
    ds_read_b64 v[210:211], v61 offset:32768
    ds_read_b64 v[214:215], v61 offset:34816
    ds_read_b64 v[218:219], v61 offset:36864
    ds_read_b64 v[222:223], v61 offset:38912
    buffer_load_dwordx4 v34, s[8:11], s69 offen offset:2048 lds
    ds_read_b64 v[226:227], v62 offset:32768
    ds_read_b64 v[230:231], v62 offset:34816
    ds_read_b64 v[234:235], v62 offset:36864
    ds_read_b64 v[238:239], v62 offset:38912
    buffer_load_dwordx4 v35, s[8:11], s69 offen offset:3072 lds
    ds_read_b64 v[242:243], v63 offset:32768
    ds_read_b64 v[246:247], v63 offset:34816
    ds_read_b64 v[250:251], v63 offset:36864
    ds_read_b64 v[254:255], v63 offset:38912
    s_add_u32 m0, s85, 4096
    s_add_u32 s69, s69, 32768
    buffer_load_dwordx4 v32, s[8:11], s69 offen lds
    s_waitcnt lgkmcnt(0)
    buffer_load_dwordx4 v33, s[8:11], s69 offen offset:1024 lds
    s_load_dwordx8 s[44:51], s[42:43], 0 glc
    buffer_load_dwordx4 v34, s[8:11], s69 offen offset:2048 lds
    buffer_load_dwordx4 v35, s[8:11], s69 offen offset:3072 lds
    s_add_u32 m0, s85, 32768
    s_lshl_b32 s69, s82, 16
    s_add_u32 s69, s69, s72
    buffer_load_dwordx4 v32, s[8:11], s69 offen lds
    buffer_load_dwordx4 v33, s[8:11], s69 offen offset:1024 lds
    buffer_load_dwordx4 v34, s[8:11], s69 offen offset:2048 lds
    buffer_load_dwordx4 v35, s[8:11], s69 offen offset:3072 lds
    s_add_u32 m0, s85, 36864
    s_add_u32 s69, s69, 32768
    buffer_load_dwordx4 v32, s[8:11], s69 offen lds
    buffer_load_dwordx4 v33, s[8:11], s69 offen offset:1024 lds
    buffer_load_dwordx4 v34, s[8:11], s69 offen offset:2048 lds
    buffer_load_dwordx4 v35, s[8:11], s69 offen offset:3072 lds
    s_xor_b32 s20, s91, 0
    s_lshl1_add_u32 s20, s33, s20
    s_lshl_b32 s20, s20, 14
    s_add_u32 s78, s20, s86
    s_add_u32 s79, s78, 8192
    s_xor_b32 s20, s91, 1
    s_lshl1_add_u32 s20, s33, s20
    s_lshl_b32 s20, s20, 14
    s_add_u32 s80, s20, s86
    s_add_u32 s81, s80, 8192
    s_add_u32 s85, s85, 98304
L_chk_4:
    s_waitcnt lgkmcnt(0)
    s_xor_b64 s[44:45], s[44:45], s[40:41]
    s_xor_b64 s[46:47], s[46:47], s[40:41]
    s_xor_b64 s[48:49], s[48:49], s[40:41]
    s_xor_b64 s[50:51], s[50:51], s[40:41]
    s_or_b64 s[44:45], s[44:45], s[46:47]
    s_or_b64 s[48:49], s[48:49], s[50:51]
    s_or_b64 s[44:45], s[44:45], s[48:49]
    s_cbranch_scc1 L_retry_6
L_ok_5:
    buffer_load_dwordx4 v[8:11], v6, s[16:19], s78 offen sc1
    buffer_load_dwordx4 v[12:15], v6, s[16:19], s78 offen offset:1024 sc1
    buffer_load_dwordx4 v[16:19], v6, s[16:19], s78 offen offset:2048 sc1
    buffer_load_dwordx4 v[20:23], v6, s[16:19], s78 offen offset:3072 sc1
    buffer_load_dwordx4 v[24:27], v7, s[16:19], s78 offen offset:1024 sc1
    buffer_load_dwordx4 v[28:31], v7, s[16:19], s78 offen sc1
    buffer_load_dwordx4 v[32:35], v7, s[16:19], s78 offen offset:3072 sc1
    buffer_load_dwordx4 v[36:39], v7, s[16:19], s78 offen offset:2048 sc1
    s_waitcnt vmcnt(8)
    s_barrier
    s_waitcnt vmcnt(7)
    v_mfma_f32_16x16x32_bf16 v[64:67], v[128:131], v[8:11], 0
    buffer_load_dwordx4 v[40:43], v6, s[16:19], s79 offen sc1
    v_mfma_f32_16x16x32_bf16 v[68:71], v[132:135], v[8:11], 0
    v_mfma_f32_16x16x32_bf16 v[72:75], v[136:139], v[8:11], 0
    buffer_load_dwordx4 v[44:47], v6, s[16:19], s79 offen offset:1024 sc1
    v_mfma_f32_16x16x32_bf16 v[76:79], v[140:143], v[8:11], 0
    s_waitcnt vmcnt(8)
    v_mfma_f32_16x16x32_bf16 v[80:83], v[128:131], v[12:15], 0
    buffer_load_dwordx4 v[48:51], v6, s[16:19], s79 offen offset:2048 sc1
    v_mfma_f32_16x16x32_bf16 v[84:87], v[132:135], v[12:15], 0
    v_mfma_f32_16x16x32_bf16 v[88:91], v[136:139], v[12:15], 0
    buffer_load_dwordx4 v[52:55], v6, s[16:19], s79 offen offset:3072 sc1
    v_mfma_f32_16x16x32_bf16 v[92:95], v[140:143], v[12:15], 0
    s_waitcnt vmcnt(9)
    v_mfma_f32_16x16x32_bf16 v[96:99], v[128:131], v[16:19], 0
    buffer_load_dwordx4 v[56:59], v7, s[16:19], s79 offen offset:1024 sc1
    v_mfma_f32_16x16x32_bf16 v[100:103], v[132:135], v[16:19], 0
    v_mfma_f32_16x16x32_bf16 v[104:107], v[136:139], v[16:19], 0
    v_mfma_f32_16x16x32_bf16 v[108:111], v[140:143], v[16:19], 0
    s_waitcnt vmcnt(9)
    v_mfma_f32_16x16x32_bf16 v[112:115], v[128:131], v[20:23], 0
    buffer_load_dwordx4 v[8:11], v7, s[16:19], s79 offen sc1
    v_mfma_f32_16x16x32_bf16 v[116:119], v[132:135], v[20:23], 0
    v_mfma_f32_16x16x32_bf16 v[120:123], v[136:139], v[20:23], 0
    v_mfma_f32_16x16x32_bf16 v[124:127], v[140:143], v[20:23], 0
    s_waitcnt vmcnt(9)
    v_mfma_f32_16x16x32_bf16 v[64:67], v[144:147], v[24:27], v[64:67]
    buffer_load_dwordx4 v[12:15], v7, s[16:19], s79 offen offset:3072 sc1
    v_mfma_f32_16x16x32_bf16 v[68:71], v[148:151], v[24:27], v[68:71]
    v_lshrrev_b32 v2, 4, v0
    v_mfma_f32_16x16x32_bf16 v[72:75], v[152:155], v[24:27], v[72:75]
    v_and_b32 v3, 15, v0
    v_mfma_f32_16x16x32_bf16 v[76:79], v[156:159], v[24:27], v[76:79]
    v_xor_b32 v3, v3, v2
    s_waitcnt vmcnt(9)
    v_mfma_f32_16x16x32_bf16 v[80:83], v[144:147], v[28:31], v[80:83]
    buffer_load_dwordx4 v[16:19], v7, s[16:19], s79 offen offset:2048 sc1
    v_mfma_f32_16x16x32_bf16 v[84:87], v[148:151], v[28:31], v[84:87]
    v_lshlrev_b32 v3, 4, v3
    v_mfma_f32_16x16x32_bf16 v[88:91], v[152:155], v[28:31], v[88:91]
    v_lshl_add_u32 v3, v2, 8, v3
    v_mfma_f32_16x16x32_bf16 v[92:95], v[156:159], v[28:31], v[92:95]
    v_add_u32 v60, s85, v3
    s_waitcnt vmcnt(9)
    v_mfma_f32_16x16x32_bf16 v[96:99], v[144:147], v[32:35], v[96:99]
    buffer_load_dwordx4 v[20:23], v6, s[16:19], s80 offen sc1
    v_mfma_f32_16x16x32_bf16 v[100:103], v[148:151], v[32:35], v[100:103]
    v_xor_b32 v61, 64, v60
    v_mfma_f32_16x16x32_bf16 v[104:107], v[152:155], v[32:35], v[104:107]
    v_xor_b32 v62, 128, v60
    v_mfma_f32_16x16x32_bf16 v[108:111], v[156:159], v[32:35], v[108:111]
    v_xor_b32 v63, 192, v60
    s_waitcnt vmcnt(9)
    v_mfma_f32_16x16x32_bf16 v[112:115], v[144:147], v[36:39], v[112:115]
    buffer_load_dwordx4 v[24:27], v6, s[16:19], s80 offen offset:1024 sc1
    v_mfma_f32_16x16x32_bf16 v[116:119], v[148:151], v[36:39], v[116:119]
    v_mfma_f32_16x16x32_bf16 v[120:123], v[152:155], v[36:39], v[120:123]
    v_mfma_f32_16x16x32_bf16 v[124:127], v[156:159], v[36:39], v[124:127]
    s_waitcnt vmcnt(9)
    v_mfma_f32_16x16x32_bf16 v[64:67], v[160:163], v[40:43], v[64:67]
    buffer_load_dwordx4 v[28:31], v6, s[16:19], s80 offen offset:2048 sc1
    v_mfma_f32_16x16x32_bf16 v[68:71], v[164:167], v[40:43], v[68:71]
    v_mfma_f32_16x16x32_bf16 v[72:75], v[168:171], v[40:43], v[72:75]
    v_mfma_f32_16x16x32_bf16 v[76:79], v[172:175], v[40:43], v[76:79]
    s_waitcnt vmcnt(9)
    v_mfma_f32_16x16x32_bf16 v[80:83], v[160:163], v[44:47], v[80:83]
    buffer_load_dwordx4 v[32:35], v6, s[16:19], s80 offen offset:3072 sc1
    v_mfma_f32_16x16x32_bf16 v[84:87], v[164:167], v[44:47], v[84:87]
    v_mfma_f32_16x16x32_bf16 v[88:91], v[168:171], v[44:47], v[88:91]
    v_mfma_f32_16x16x32_bf16 v[92:95], v[172:175], v[44:47], v[92:95]
    s_waitcnt vmcnt(9)
    v_mfma_f32_16x16x32_bf16 v[96:99], v[160:163], v[48:51], v[96:99]
    buffer_load_dwordx4 v[36:39], v7, s[16:19], s80 offen offset:1024 sc1
    v_mfma_f32_16x16x32_bf16 v[100:103], v[164:167], v[48:51], v[100:103]
    v_mfma_f32_16x16x32_bf16 v[104:107], v[168:171], v[48:51], v[104:107]
    v_mfma_f32_16x16x32_bf16 v[108:111], v[172:175], v[48:51], v[108:111]
    s_waitcnt vmcnt(9)
    v_mfma_f32_16x16x32_bf16 v[112:115], v[160:163], v[52:55], v[112:115]
    buffer_load_dwordx4 v[40:43], v7, s[16:19], s80 offen sc1
    v_mfma_f32_16x16x32_bf16 v[116:119], v[164:167], v[52:55], v[116:119]
    v_mfma_f32_16x16x32_bf16 v[120:123], v[168:171], v[52:55], v[120:123]
    v_mfma_f32_16x16x32_bf16 v[124:127], v[172:175], v[52:55], v[124:127]
    s_waitcnt vmcnt(9)
    v_mfma_f32_16x16x32_bf16 v[64:67], v[176:179], v[56:59], v[64:67]
    buffer_load_dwordx4 v[44:47], v7, s[16:19], s80 offen offset:3072 sc1
    v_mfma_f32_16x16x32_bf16 v[68:71], v[180:183], v[56:59], v[68:71]
    v_mfma_f32_16x16x32_bf16 v[72:75], v[184:187], v[56:59], v[72:75]
    v_mfma_f32_16x16x32_bf16 v[76:79], v[188:191], v[56:59], v[76:79]
    s_waitcnt vmcnt(9)
    v_mfma_f32_16x16x32_bf16 v[80:83], v[176:179], v[8:11], v[80:83]
    buffer_load_dwordx4 v[48:51], v7, s[16:19], s80 offen offset:2048 sc1
    v_mfma_f32_16x16x32_bf16 v[84:87], v[180:183], v[8:11], v[84:87]
    v_mfma_f32_16x16x32_bf16 v[88:91], v[184:187], v[8:11], v[88:91]
    v_mfma_f32_16x16x32_bf16 v[92:95], v[188:191], v[8:11], v[92:95]
    s_waitcnt vmcnt(9)
    v_mfma_f32_16x16x32_bf16 v[96:99], v[176:179], v[12:15], v[96:99]
    buffer_load_dwordx4 v[52:55], v6, s[16:19], s81 offen sc1
    v_mfma_f32_16x16x32_bf16 v[100:103], v[180:183], v[12:15], v[100:103]
    v_mfma_f32_16x16x32_bf16 v[104:107], v[184:187], v[12:15], v[104:107]
    v_mfma_f32_16x16x32_bf16 v[108:111], v[188:191], v[12:15], v[108:111]
    s_waitcnt vmcnt(9)
    v_mfma_f32_16x16x32_bf16 v[112:115], v[176:179], v[16:19], v[112:115]
    buffer_load_dwordx4 v[56:59], v6, s[16:19], s81 offen offset:1024 sc1
    v_mfma_f32_16x16x32_bf16 v[116:119], v[180:183], v[16:19], v[116:119]
    v_mfma_f32_16x16x32_bf16 v[120:123], v[184:187], v[16:19], v[120:123]
    v_mfma_f32_16x16x32_bf16 v[124:127], v[188:191], v[16:19], v[124:127]
    s_waitcnt vmcnt(9)
    v_mfma_f32_16x16x32_bf16 v[64:67], v[192:195], v[20:23], v[64:67]
    buffer_load_dwordx4 v[8:11], v6, s[16:19], s81 offen offset:2048 sc1
    v_mfma_f32_16x16x32_bf16 v[68:71], v[196:199], v[20:23], v[68:71]
    v_mfma_f32_16x16x32_bf16 v[72:75], v[200:203], v[20:23], v[72:75]
    v_mfma_f32_16x16x32_bf16 v[76:79], v[204:207], v[20:23], v[76:79]
    s_waitcnt vmcnt(9)
    v_mfma_f32_16x16x32_bf16 v[80:83], v[192:195], v[24:27], v[80:83]
    buffer_load_dwordx4 v[12:15], v6, s[16:19], s81 offen offset:3072 sc1
    v_mfma_f32_16x16x32_bf16 v[84:87], v[196:199], v[24:27], v[84:87]
    v_mfma_f32_16x16x32_bf16 v[88:91], v[200:203], v[24:27], v[88:91]
    v_mfma_f32_16x16x32_bf16 v[92:95], v[204:207], v[24:27], v[92:95]
    s_waitcnt vmcnt(9)
    v_mfma_f32_16x16x32_bf16 v[96:99], v[192:195], v[28:31], v[96:99]
    buffer_load_dwordx4 v[16:19], v7, s[16:19], s81 offen offset:1024 sc1
    v_mfma_f32_16x16x32_bf16 v[100:103], v[196:199], v[28:31], v[100:103]
    v_mfma_f32_16x16x32_bf16 v[104:107], v[200:203], v[28:31], v[104:107]
    v_mfma_f32_16x16x32_bf16 v[108:111], v[204:207], v[28:31], v[108:111]
    s_waitcnt vmcnt(9)
    v_mfma_f32_16x16x32_bf16 v[112:115], v[192:195], v[32:35], v[112:115]
    buffer_load_dwordx4 v[20:23], v7, s[16:19], s81 offen sc1
    v_mfma_f32_16x16x32_bf16 v[116:119], v[196:199], v[32:35], v[116:119]
    v_mfma_f32_16x16x32_bf16 v[120:123], v[200:203], v[32:35], v[120:123]
    v_mfma_f32_16x16x32_bf16 v[124:127], v[204:207], v[32:35], v[124:127]
    s_waitcnt vmcnt(9)
    v_mfma_f32_16x16x32_bf16 v[64:67], v[208:211], v[36:39], v[64:67]
    buffer_load_dwordx4 v[24:27], v7, s[16:19], s81 offen offset:3072 sc1
    v_mfma_f32_16x16x32_bf16 v[68:71], v[212:215], v[36:39], v[68:71]
    v_mfma_f32_16x16x32_bf16 v[72:75], v[216:219], v[36:39], v[72:75]
    v_mfma_f32_16x16x32_bf16 v[76:79], v[220:223], v[36:39], v[76:79]
    s_waitcnt vmcnt(9)
    v_mfma_f32_16x16x32_bf16 v[80:83], v[208:211], v[40:43], v[80:83]
    buffer_load_dwordx4 v[28:31], v7, s[16:19], s81 offen offset:2048 sc1
    v_mfma_f32_16x16x32_bf16 v[84:87], v[212:215], v[40:43], v[84:87]
    v_mfma_f32_16x16x32_bf16 v[88:91], v[216:219], v[40:43], v[88:91]
    v_mfma_f32_16x16x32_bf16 v[92:95], v[220:223], v[40:43], v[92:95]
    s_waitcnt vmcnt(9)
    v_mfma_f32_16x16x32_bf16 v[96:99], v[208:211], v[44:47], v[96:99]
    v_mfma_f32_16x16x32_bf16 v[100:103], v[212:215], v[44:47], v[100:103]
    v_mfma_f32_16x16x32_bf16 v[104:107], v[216:219], v[44:47], v[104:107]
    v_mfma_f32_16x16x32_bf16 v[108:111], v[220:223], v[44:47], v[108:111]
    s_waitcnt vmcnt(8)
    v_mfma_f32_16x16x32_bf16 v[112:115], v[208:211], v[48:51], v[112:115]
    v_mfma_f32_16x16x32_bf16 v[116:119], v[212:215], v[48:51], v[116:119]
    v_mfma_f32_16x16x32_bf16 v[120:123], v[216:219], v[48:51], v[120:123]
    v_mfma_f32_16x16x32_bf16 v[124:127], v[220:223], v[48:51], v[124:127]
    s_waitcnt vmcnt(7)
    v_mfma_f32_16x16x32_bf16 v[64:67], v[224:227], v[52:55], v[64:67]
    v_mfma_f32_16x16x32_bf16 v[68:71], v[228:231], v[52:55], v[68:71]
    v_mfma_f32_16x16x32_bf16 v[72:75], v[232:235], v[52:55], v[72:75]
    v_mfma_f32_16x16x32_bf16 v[76:79], v[236:239], v[52:55], v[76:79]
    s_waitcnt vmcnt(6)
    v_mfma_f32_16x16x32_bf16 v[80:83], v[224:227], v[56:59], v[80:83]
    v_mfma_f32_16x16x32_bf16 v[84:87], v[228:231], v[56:59], v[84:87]
    v_mfma_f32_16x16x32_bf16 v[88:91], v[232:235], v[56:59], v[88:91]
    v_mfma_f32_16x16x32_bf16 v[92:95], v[236:239], v[56:59], v[92:95]
    s_waitcnt vmcnt(5)
    v_mfma_f32_16x16x32_bf16 v[96:99], v[224:227], v[8:11], v[96:99]
    v_mfma_f32_16x16x32_bf16 v[100:103], v[228:231], v[8:11], v[100:103]
    v_mfma_f32_16x16x32_bf16 v[104:107], v[232:235], v[8:11], v[104:107]
    v_mfma_f32_16x16x32_bf16 v[108:111], v[236:239], v[8:11], v[108:111]
    s_waitcnt vmcnt(4)
    v_mfma_f32_16x16x32_bf16 v[112:115], v[224:227], v[12:15], v[112:115]
    v_mfma_f32_16x16x32_bf16 v[116:119], v[228:231], v[12:15], v[116:119]
    v_mfma_f32_16x16x32_bf16 v[120:123], v[232:235], v[12:15], v[120:123]
    v_mfma_f32_16x16x32_bf16 v[124:127], v[236:239], v[12:15], v[124:127]
    s_barrier
    s_waitcnt vmcnt(3)
    v_mfma_f32_16x16x32_bf16 v[64:67], v[240:243], v[16:19], v[64:67]
    v_mfma_f32_16x16x32_bf16 v[68:71], v[244:247], v[16:19], v[68:71]
    v_mfma_f32_16x16x32_bf16 v[72:75], v[248:251], v[16:19], v[72:75]
    v_mfma_f32_16x16x32_bf16 v[76:79], v[252:255], v[16:19], v[76:79]
    s_waitcnt vmcnt(2)
    v_mfma_f32_16x16x32_bf16 v[80:83], v[240:243], v[20:23], v[80:83]
    v_mfma_f32_16x16x32_bf16 v[84:87], v[244:247], v[20:23], v[84:87]
    v_mfma_f32_16x16x32_bf16 v[88:91], v[248:251], v[20:23], v[88:91]
    v_mfma_f32_16x16x32_bf16 v[92:95], v[252:255], v[20:23], v[92:95]
    s_waitcnt vmcnt(1)
    v_mfma_f32_16x16x32_bf16 v[96:99], v[240:243], v[24:27], v[96:99]
    v_mfma_f32_16x16x32_bf16 v[100:103], v[244:247], v[24:27], v[100:103]
    v_mfma_f32_16x16x32_bf16 v[104:107], v[248:251], v[24:27], v[104:107]
    v_mfma_f32_16x16x32_bf16 v[108:111], v[252:255], v[24:27], v[108:111]
    s_waitcnt vmcnt(0)
    v_mfma_f32_16x16x32_bf16 v[112:115], v[240:243], v[28:31], v[112:115]
    v_mfma_f32_16x16x32_bf16 v[116:119], v[244:247], v[28:31], v[116:119]
    v_mfma_f32_16x16x32_bf16 v[120:123], v[248:251], v[28:31], v[120:123]
    v_mfma_f32_16x16x32_bf16 v[124:127], v[252:255], v[28:31], v[124:127]
    s_mov_b32 s4, s36
    s_mov_b32 s5, s37
    s_mov_b32 s6, 2097152
    s_mov_b32 s7, 0x00020000
    s_mov_b32 s12, s62
    s_mov_b32 s13, s63
    s_mov_b32 s14, 4194304
    s_mov_b32 s15, 0x00020000
    s_lshl2_add_u32 s20, s31, s33
    s_lshl_b32 s68, s20, 14
    s_lshl_b32 s21, s32, 7
    s_add_u32 s68, s68, s21
    s_lshl_b32 s20, s20, 7
    s_add_u32 s20, s20, 4096
    v_lshrrev_b32 v148, 4, v0
    v_and_b32 v149, 15, v0
    v_lshlrev_b32 v150, 3, v149
    v_lshl_add_u32 v151, v148, 10, v150
    v_lshlrev_b32 v148, 3, v148
    v_add_u32 v150, s21, v150
    s_mov_b32 s69, s68
    buffer_load_dwordx2 v[128:129], v151, s[4:7], s69 offen
    buffer_load_dword v136, v148, s[16:19], s20 offen sc1
    s_add_u32 s69, s69, 4096
    buffer_load_dwordx2 v[130:131], v151, s[4:7], s69 offen
    buffer_load_dword v137, v148, s[16:19], s20 offen offset:32 sc1
    s_add_u32 s69, s69, 4096
    buffer_load_dwordx2 v[132:133], v151, s[4:7], s69 offen
    buffer_load_dword v138, v148, s[16:19], s20 offen offset:64 sc1
    s_add_u32 s69, s69, 4096
    buffer_load_dwordx2 v[134:135], v151, s[4:7], s69 offen
    buffer_load_dword v139, v148, s[16:19], s20 offen offset:96 sc1
    global_load_dwordx2 v[140:141], v150, s[52:53]
    ds_write_b128 v60, v[64:67] offset:0
    ds_write_b128 v61, v[68:71] offset:1024
    ds_write_b128 v62, v[72:75] offset:2048
    ds_write_b128 v63, v[76:79] offset:3072
    ds_write_b128 v60, v[80:83] offset:4096
    ds_write_b128 v61, v[84:87] offset:5120
    ds_write_b128 v62, v[88:91] offset:6144
    ds_write_b128 v63, v[92:95] offset:7168
    ds_write_b128 v60, v[96:99] offset:32768
    ds_write_b128 v61, v[100:103] offset:33792
    ds_write_b128 v62, v[104:107] offset:34816
    ds_write_b128 v63, v[108:111] offset:35840
    ds_write_b128 v60, v[112:115] offset:36864
    ds_write_b128 v61, v[116:119] offset:37888
    ds_write_b128 v62, v[120:123] offset:38912
    ds_write_b128 v63, v[124:127] offset:39936
    s_waitcnt vmcnt(0)
    v_lshrrev_b32 v142, 4, v0
    v_and_b32 v143, 15, v0
    v_lshlrev_b32 v145, 3, v143
    v_lshl_add_u32 v145, v142, 10, v145
    s_lshl_b32 s20, s33, 2
    v_add_u32 v147, s20, v142
    v_xor_b32 v147, v147, v143
    v_lshlrev_b32 v147, 4, v147
    v_lshl_add_u32 v147, v143, 8, v147
    v_add_u32 v146, 98304, v147
    v_lshlrev_b32 v145, 1, v145
    s_lshl_b32 s68, s68, 1
    s_mov_b32 s22, 1060205080
    v_lshlrev_b32 v148, 16, v140
    v_and_b32 v149, s76, v140
    v_lshlrev_b32 v150, 16, v141
    v_and_b32 v151, s76, v141
    v_and_b32 v153, s76, v136
    v_rcp_f32 v153, v153
    v_lshlrev_b32 v152, 16, v136
    v_lshlrev_b32 v160, 16, v128
    v_and_b32 v161, s76, v128
    v_lshlrev_b32 v162, 16, v129
    v_and_b32 v163, s76, v129
    v_sub_f32 v176, v160, v152
    v_sub_f32 v177, v161, v152
    v_sub_f32 v178, v162, v152
    v_sub_f32 v179, v163, v152
    v_mul_f32 v176, v153, v176
    v_mul_f32 v177, v153, v177
    v_mul_f32 v178, v153, v178
    v_mul_f32 v179, v153, v179
    v_and_b32 v153, s76, v137
    v_rcp_f32 v153, v153
    v_lshlrev_b32 v152, 16, v137
    v_lshlrev_b32 v164, 16, v130
    v_and_b32 v165, s76, v130
    v_lshlrev_b32 v166, 16, v131
    v_and_b32 v167, s76, v131
    v_sub_f32 v180, v164, v152
    v_sub_f32 v181, v165, v152
    v_sub_f32 v182, v166, v152
    v_sub_f32 v183, v167, v152
    v_mul_f32 v180, v153, v180
    v_mul_f32 v181, v153, v181
    v_mul_f32 v182, v153, v182
    v_mul_f32 v183, v153, v183
    v_and_b32 v153, s76, v138
    v_rcp_f32 v153, v153
    v_lshlrev_b32 v152, 16, v138
    v_lshlrev_b32 v168, 16, v132
    v_and_b32 v169, s76, v132
    v_lshlrev_b32 v170, 16, v133
    v_and_b32 v171, s76, v133
    v_sub_f32 v184, v168, v152
    v_sub_f32 v185, v169, v152
    v_sub_f32 v186, v170, v152
    v_sub_f32 v187, v171, v152
    v_mul_f32 v184, v153, v184
    v_mul_f32 v185, v153, v185
    v_mul_f32 v186, v153, v186
    v_mul_f32 v187, v153, v187
    v_and_b32 v153, s76, v139
    v_rcp_f32 v153, v153
    v_lshlrev_b32 v152, 16, v139
    v_lshlrev_b32 v172, 16, v134
    v_and_b32 v173, s76, v134
    v_lshlrev_b32 v174, 16, v135
    v_and_b32 v175, s76, v135
    v_sub_f32 v188, v172, v152
    v_sub_f32 v189, v173, v152
    v_sub_f32 v190, v174, v152
    v_sub_f32 v191, v175, v152
    v_mul_f32 v188, v153, v188
    v_mul_f32 v189, v153, v189
    v_mul_f32 v190, v153, v190
    v_mul_f32 v191, v153, v191
    s_waitcnt lgkmcnt(0)
    s_barrier
    ds_read_b128 v[64:67], v146 offset:0
    ds_read_b128 v[68:71], v146 offset:8192
    ds_read_b128 v[72:75], v146 offset:16384
    ds_read_b128 v[76:79], v146 offset:24576
    ds_read_b128 v[80:83], v146 offset:4096
    ds_read_b128 v[84:87], v146 offset:12288
    ds_read_b128 v[88:91], v146 offset:20480
    ds_read_b128 v[92:95], v146 offset:28672
    ds_read_b128 v[96:99], v146 offset:32768
    ds_read_b128 v[100:103], v146 offset:40960
    ds_read_b128 v[104:107], v146 offset:49152
    ds_read_b128 v[108:111], v146 offset:57344
    ds_read_b128 v[112:115], v146 offset:36864
    ds_read_b128 v[116:119], v146 offset:45056
    ds_read_b128 v[120:123], v146 offset:53248
    ds_read_b128 v[124:127], v146 offset:61440
    s_waitcnt lgkmcnt(12)
    v_fma_f32 v176, v176, v148, v64
    v_add_f32 v68, v68, v72
    v_fma_f32 v177, v177, v149, v65
    v_add_f32 v69, v69, v73
    v_fma_f32 v178, v178, v150, v66
    v_add_f32 v70, v70, v74
    v_fma_f32 v179, v179, v151, v67
    v_add_f32 v71, v71, v75
    v_add_f32 v176, v176, v76
    v_add_f32 v177, v177, v77
    v_add_f32 v178, v178, v78
    v_add_f32 v179, v179, v79
    v_add_f32 v176, v176, v68
    v_add_f32 v177, v177, v69
    v_add_f32 v178, v178, v70
    v_add_f32 v179, v179, v71
    v_mul_f32 v176, s22, v176
    v_mul_f32 v177, s22, v177
    v_mul_f32 v178, s22, v178
    v_mul_f32 v179, s22, v179
    s_waitcnt lgkmcnt(8)
    v_fma_f32 v180, v180, v148, v80
    v_add_f32 v84, v84, v88
    v_fma_f32 v181, v181, v149, v81
    v_add_f32 v85, v85, v89
    v_fma_f32 v182, v182, v150, v82
    v_add_f32 v86, v86, v90
    v_fma_f32 v183, v183, v151, v83
    v_add_f32 v87, v87, v91
    v_add_f32 v180, v180, v92
    v_add_f32 v181, v181, v93
    v_add_f32 v182, v182, v94
    v_add_f32 v183, v183, v95
    v_add_f32 v180, v180, v84
    v_add_f32 v181, v181, v85
    v_add_f32 v182, v182, v86
    v_add_f32 v183, v183, v87
    v_mul_f32 v180, s22, v180
    v_mul_f32 v181, s22, v181
    v_mul_f32 v182, s22, v182
    v_mul_f32 v183, s22, v183
    s_waitcnt lgkmcnt(4)
    v_fma_f32 v184, v184, v148, v96
    v_add_f32 v100, v100, v104
    v_fma_f32 v185, v185, v149, v97
    v_add_f32 v101, v101, v105
    v_fma_f32 v186, v186, v150, v98
    v_add_f32 v102, v102, v106
    v_fma_f32 v187, v187, v151, v99
    v_add_f32 v103, v103, v107
    v_add_f32 v184, v184, v108
    v_add_f32 v185, v185, v109
    v_add_f32 v186, v186, v110
    v_add_f32 v187, v187, v111
    v_add_f32 v184, v184, v100
    v_add_f32 v185, v185, v101
    v_add_f32 v186, v186, v102
    v_add_f32 v187, v187, v103
    v_mul_f32 v184, s22, v184
    v_mul_f32 v185, s22, v185
    v_mul_f32 v186, s22, v186
    v_mul_f32 v187, s22, v187
    s_waitcnt lgkmcnt(0)
    v_fma_f32 v188, v188, v148, v112
    v_add_f32 v116, v116, v120
    v_fma_f32 v189, v189, v149, v113
    v_add_f32 v117, v117, v121
    v_fma_f32 v190, v190, v150, v114
    v_add_f32 v118, v118, v122
    v_fma_f32 v191, v191, v151, v115
    v_add_f32 v119, v119, v123
    v_add_f32 v188, v188, v124
    v_add_f32 v189, v189, v125
    v_add_f32 v190, v190, v126
    v_add_f32 v191, v191, v127
    v_add_f32 v188, v188, v116
    v_add_f32 v189, v189, v117
    v_add_f32 v190, v190, v118
    v_add_f32 v191, v191, v119
    v_mul_f32 v188, s22, v188
    v_mul_f32 v189, s22, v189
    v_mul_f32 v190, s22, v190
    v_mul_f32 v191, s22, v191
    s_barrier
    ds_read_b128 v[64:67], v147 offset:0
    ds_read_b128 v[68:71], v147 offset:8192
    ds_read_b128 v[72:75], v147 offset:16384
    ds_read_b128 v[76:79], v147 offset:24576
    s_waitcnt lgkmcnt(2)
    v_add_f32 v64, v64, v68
    v_add_f32 v65, v65, v69
    v_add_f32 v66, v66, v70
    v_add_f32 v67, v67, v71
    s_waitcnt lgkmcnt(0)
    v_add_f32 v72, v72, v76
    v_add_f32 v73, v73, v77
    v_add_f32 v74, v74, v78
    v_add_f32 v75, v75, v79
    v_add_f32 v64, v64, v72
    v_add_f32 v65, v65, v73
    v_add_f32 v66, v66, v74
    v_add_f32 v67, v67, v75
    v_exp_f32_e64 v68, -v64
    v_exp_f32_e64 v69, -v65
    v_exp_f32_e64 v70, -v66
    v_exp_f32_e64 v71, -v67
    v_mul_f32 v176, v176, v64
    v_mul_f32 v177, v177, v65
    v_mul_f32 v178, v178, v66
    v_mul_f32 v179, v179, v67
    v_add_f32 v68, 1.0, v68
    v_add_f32 v69, 1.0, v69
    v_add_f32 v70, 1.0, v70
    v_add_f32 v71, 1.0, v71
    v_rcp_f32 v68, v68
    v_rcp_f32 v69, v69
    v_rcp_f32 v70, v70
    v_rcp_f32 v71, v71
    s_nop 0
    v_fmac_f32 v160, v176, v68
    v_fmac_f32 v161, v177, v69
    v_fmac_f32 v162, v178, v70
    v_fmac_f32 v163, v179, v71
    buffer_store_dwordx4 v[160:163], v145, s[12:15], s68 offen sc1
    s_add_u32 s68, s68, 8192
    s_barrier
    ds_read_b128 v[80:83], v147 offset:4096
    ds_read_b128 v[84:87], v147 offset:12288
    ds_read_b128 v[88:91], v147 offset:20480
    ds_read_b128 v[92:95], v147 offset:28672
    s_waitcnt lgkmcnt(2)
    v_add_f32 v80, v80, v84
    v_add_f32 v81, v81, v85
    v_add_f32 v82, v82, v86
    v_add_f32 v83, v83, v87
    s_waitcnt lgkmcnt(0)
    v_add_f32 v88, v88, v92
    v_add_f32 v89, v89, v93
    v_add_f32 v90, v90, v94
    v_add_f32 v91, v91, v95
    v_add_f32 v80, v80, v88
    v_add_f32 v81, v81, v89
    v_add_f32 v82, v82, v90
    v_add_f32 v83, v83, v91
    v_exp_f32_e64 v84, -v80
    v_exp_f32_e64 v85, -v81
    v_exp_f32_e64 v86, -v82
    v_exp_f32_e64 v87, -v83
    v_mul_f32 v180, v180, v80
    v_mul_f32 v181, v181, v81
    v_mul_f32 v182, v182, v82
    v_mul_f32 v183, v183, v83
    v_add_f32 v84, 1.0, v84
    v_add_f32 v85, 1.0, v85
    v_add_f32 v86, 1.0, v86
    v_add_f32 v87, 1.0, v87
    v_rcp_f32 v84, v84
    v_rcp_f32 v85, v85
    v_rcp_f32 v86, v86
    v_rcp_f32 v87, v87
    s_nop 0
    v_fmac_f32 v164, v180, v84
    v_fmac_f32 v165, v181, v85
    v_fmac_f32 v166, v182, v86
    v_fmac_f32 v167, v183, v87
    buffer_store_dwordx4 v[164:167], v145, s[12:15], s68 offen sc1
    s_add_u32 s68, s68, 8192
    s_barrier
    ds_read_b128 v[96:99], v147 offset:32768
    ds_read_b128 v[100:103], v147 offset:40960
    ds_read_b128 v[104:107], v147 offset:49152
    ds_read_b128 v[108:111], v147 offset:57344
    s_waitcnt lgkmcnt(2)
    v_add_f32 v96, v96, v100
    v_add_f32 v97, v97, v101
    v_add_f32 v98, v98, v102
    v_add_f32 v99, v99, v103
    s_waitcnt lgkmcnt(0)
    v_add_f32 v104, v104, v108
    v_add_f32 v105, v105, v109
    v_add_f32 v106, v106, v110
    v_add_f32 v107, v107, v111
    v_add_f32 v96, v96, v104
    v_add_f32 v97, v97, v105
    v_add_f32 v98, v98, v106
    v_add_f32 v99, v99, v107
    v_exp_f32_e64 v100, -v96
    v_exp_f32_e64 v101, -v97
    v_exp_f32_e64 v102, -v98
    v_exp_f32_e64 v103, -v99
    v_mul_f32 v184, v184, v96
    v_mul_f32 v185, v185, v97
    v_mul_f32 v186, v186, v98
    v_mul_f32 v187, v187, v99
    v_add_f32 v100, 1.0, v100
    v_add_f32 v101, 1.0, v101
    v_add_f32 v102, 1.0, v102
    v_add_f32 v103, 1.0, v103
    v_rcp_f32 v100, v100
    v_rcp_f32 v101, v101
    v_rcp_f32 v102, v102
    v_rcp_f32 v103, v103
    s_nop 0
    v_fmac_f32 v168, v184, v100
    v_fmac_f32 v169, v185, v101
    v_fmac_f32 v170, v186, v102
    v_fmac_f32 v171, v187, v103
    buffer_store_dwordx4 v[168:171], v145, s[12:15], s68 offen sc1
    s_add_u32 s68, s68, 8192
    s_barrier
    ds_read_b128 v[112:115], v147 offset:36864
    ds_read_b128 v[116:119], v147 offset:45056
    ds_read_b128 v[120:123], v147 offset:53248
    ds_read_b128 v[124:127], v147 offset:61440
    s_waitcnt lgkmcnt(2)
    v_pk_add_f32 v[112:113], v[112:113], v[116:117]
    v_pk_add_f32 v[114:115], v[114:115], v[118:119]
    s_waitcnt lgkmcnt(0)
    v_pk_add_f32 v[120:121], v[120:121], v[124:125]
    v_pk_add_f32 v[122:123], v[122:123], v[126:127]
    v_pk_add_f32 v[112:113], v[112:113], v[120:121]
    v_pk_add_f32 v[114:115], v[114:115], v[122:123]
    v_exp_f32_e64 v116, -v112
    v_exp_f32_e64 v117, -v113
    v_exp_f32_e64 v118, -v114
    v_exp_f32_e64 v119, -v115
    v_pk_mul_f32 v[188:189], v[188:189], v[112:113]
    v_pk_mul_f32 v[190:191], v[190:191], v[114:115]
    v_pk_add_f32 v[116:117], v[116:117], 1.0 op_sel_hi:[1,0]
    v_pk_add_f32 v[118:119], v[118:119], 1.0 op_sel_hi:[1,0]
    v_rcp_f32 v116, v116
    v_rcp_f32 v117, v117
    v_rcp_f32 v118, v118
    v_rcp_f32 v119, v119
    v_pk_fma_f32 v[172:173], v[188:189], v[116:117], v[172:173]
    v_pk_fma_f32 v[174:175], v[190:191], v[118:119], v[174:175]
    buffer_store_dwordx4 v[172:175], v145, s[12:15], s68 offen sc1
    s_branch L_fin
L_X:
    v_lshrrev_b32 v2, 4, v0
    v_and_b32 v3, 7, v0
    v_xor_b32 v3, v3, v2
    v_lshlrev_b32 v3, 4, v3
    v_lshrrev_b32 v4, 3, v0
    v_lshl_add_u32 v36, v4, 10, v3
    v_lshrrev_b32 v4, 5, v0
    v_mul_u32_u24 v4, 12288, v4
    v_add_u32 v32, v4, v36
    v_xor_b32 v33, 64, v32
    v_xor_b32 v37, 64, v36
    v_add_u32 v33, 31744, v33
    v_add_u32 v37, 7168, v37
    v_add_u32 v34, 2048, v32
    v_add_u32 v35, 2048, v33
    s_and_b32 s21, s33, 1
    s_lshl1_add_u32 s71, s27, s89
    s_lshl3_add_u32 s71, s71, s21
    s_lshl_b32 s71, s71, 13
    s_lshl1_add_u32 s72, s28, s89
    s_lshl_b32 s72, s72, 14
    s_lshl_b32 s74, s33, 12
    s_lshl1_add_u32 s75, s21, s89
    s_lshl_b32 s75, s75, 11
    s_cmp_eq_u32 s21, 0
    s_waitcnt lgkmcnt(0)
    s_cselect_b32 s8, s42, s44
    s_cselect_b32 s9, s43, s45
    s_mov_b32 s10, 524288
    s_mov_b32 s11, 0x00020000
    s_mov_b32 s4, s36
    s_mov_b32 s5, s37
    s_mov_b32 s6, 2097152
    s_mov_b32 s7, 0x00020000
    s_add_u32 s20, s30, 0
    s_and_b32 s20, s20, 7
    s_lshl_b32 s21, s20, 7
    s_add_u32 m0, s75, 139264
    s_add_u32 s69, s72, s21
    buffer_load_dwordx4 v36, s[8:11], s69 offen lds
    buffer_load_dwordx4 v37, s[8:11], s69 offen offset:1024 lds
    s_add_u32 m0, s74, 8192
    s_add_u32 s68, s71, s21
    buffer_load_dwordx4 v32, s[4:7], s68 offen lds
    buffer_load_dwordx4 v33, s[4:7], s68 offen offset:1024 lds
    buffer_load_dwordx4 v34, s[4:7], s68 offen offset:2048 lds
    buffer_load_dwordx4 v35, s[4:7], s68 offen offset:3072 lds
    s_mov_b32 s16, s66
    s_mov_b32 s17, s67
    s_mov_b32 s18, 268435456
    s_mov_b32 s19, 0x00020000
    buffer_load_dword v1, off, s[16:19], 0 sc1
    v_and_b32 v2, 15, v0
    s_lshr_b32 s20, s28, 2
    s_lshl_b32 s21, s28, 1
    s_sub_u32 s20, s21, s20
    s_lshl1_add_u32 s20, s20, s33
    s_lshl_b32 s20, s20, 5
    v_add_u32 v4, s20, v2
    v_min_u32 v4, 1775, v4
    v_lshlrev_b32 v4, 1, v4
    global_load_ushort v26, v4, s[58:59]
    global_load_ushort v27, v4, s[58:59] offset:32
    v_and_b32 v2, 15, v0
    v_bfe_u32 v3, v0, 1, 3
    v_lshrrev_b32 v4, 4, v0
    v_xor_b32 v3, v3, v4
    v_lshlrev_b32 v3, 4, v3
    v_lshl_add_u32 v16, v2, 7, v3
    s_add_u32 s20, s74, 8192
    v_add_u32 v16, s20, v16
    v_xor_b32 v17, 64, v16
    s_add_u32 s20, s30, 1
    s_and_b32 s20, s20, 7
    s_lshl_b32 s21, s20, 7
    s_add_u32 m0, s75, 147456
    s_add_u32 s69, s72, s21
    buffer_load_dwordx4 v36, s[8:11], s69 offen lds
    buffer_load_dwordx4 v37, s[8:11], s69 offen offset:1024 lds
    s_add_u32 m0, s74, 24576
    s_add_u32 s68, s71, s21
    buffer_load_dwordx4 v32, s[4:7], s68 offen lds
    buffer_load_dwordx4 v33, s[4:7], s68 offen offset:1024 lds
    buffer_load_dwordx4 v34, s[4:7], s68 offen offset:2048 lds
    buffer_load_dwordx4 v35, s[4:7], s68 offen offset:3072 lds
    s_waitcnt vmcnt(9)
    s_barrier
    s_add_u32 s20, s30, 2
    s_and_b32 s20, s20, 7
    s_lshl_b32 s21, s20, 7
    s_add_u32 m0, s75, 155648
    s_add_u32 s69, s72, s21
    buffer_load_dwordx4 v36, s[8:11], s69 offen lds
    buffer_load_dwordx4 v37, s[8:11], s69 offen offset:1024 lds
    s_add_u32 m0, s74, 40960
    s_add_u32 s68, s71, s21
    buffer_load_dwordx4 v32, s[4:7], s68 offen lds
    buffer_load_dwordx4 v33, s[4:7], s68 offen offset:1024 lds
    buffer_load_dwordx4 v34, s[4:7], s68 offen offset:2048 lds
    buffer_load_dwordx4 v35, s[4:7], s68 offen offset:3072 lds
    ds_read_b128 v[128:131], v16 offset:0
    ds_read_b128 v[132:135], v16 offset:2048
    ds_read_b128 v[136:139], v17 offset:0
    ds_read_b128 v[140:143], v17 offset:2048
    s_lshr_b32 s20, s28, 2
    s_lshl_b32 s29, s28, 1
    s_sub_u32 s29, s29, s20
    s_and_b32 s87, s26, 7
    s_lshr_b32 s20, s25, 1
    s_lshl3_add_u32 s31, s20, s87
    s_and_b32 s20, s25, 1
    s_lshr_b32 s32, s26, 3
    s_lshl2_add_u32 s32, s20, s32
    s_mov_b32 s77, 400000
    s_lshl1_add_u32 s88, s27, s89
    s_mov_b32 s76, 0xffff0000
    s_mul_i32 s87, s87, 1
    s_mul_i32 s20, s25, 0
    s_add_u32 s87, s87, s20
    s_add_u32 s91, s87, 0
    s_and_b32 s91, s91, 1
    s_mul_i32 s86, s31, 360448
    s_add_u32 s86, s86, 2097152
    v_lshlrev_b32 v6, 4, v0
    v_add_u32 v7, 4096, v6
    s_waitcnt vmcnt(6)
    s_mov_b32 s20, 0x9E3779B1
    v_mul_lo_u32 v1, v1, s20
    v_add_u32 v1, 0x7F4A7C15, v1
    s_barrier
    s_add_u32 s20, s30, 3
    s_and_b32 s20, s20, 7
    s_lshl_b32 s21, s20, 7
    s_add_u32 m0, s75, 139264
    s_add_u32 s69, s72, s21
    buffer_load_dwordx4 v36, s[8:11], s69 offen lds
    buffer_load_dwordx4 v37, s[8:11], s69 offen offset:1024 lds
    s_add_u32 m0, s74, 57344
    s_add_u32 s68, s71, s21
    buffer_load_dwordx4 v32, s[4:7], s68 offen lds
    buffer_load_dwordx4 v33, s[4:7], s68 offen offset:1024 lds
    buffer_load_dwordx4 v34, s[4:7], s68 offen offset:2048 lds
    buffer_load_dwordx4 v35, s[4:7], s68 offen offset:3072 lds
    ds_read_b128 v[144:147], v16 offset:16384
    ds_read_b128 v[148:151], v16 offset:18432
    ds_read_b128 v[152:155], v17 offset:16384
    ds_read_b128 v[156:159], v17 offset:18432
    v_lshrrev_b32 v2, 4, v0
    v_bfe_u32 v3, v0, 1, 3
    s_and_b32 s20, s33, 1
    v_lshl_or_b32 v4, v2, 1, s20
    v_xor_b32 v3, v3, v4
    v_mul_u32_u24 v38, 3584, v2
    v_lshl_add_u32 v38, v3, 5, v38
    v_and_b32 v4, 1, v0
    v_lshl_add_u32 v38, v4, 4, v38
    s_and_b32 s21, s28, 3
    s_cmp_eq_u32 s21, 3
    s_cselect_b32 s21, 0x40000000, 0
    v_lshrrev_b32 v3, 2, v3
    v_mul_lo_u32 v3, v3, s21
    v_add_u32 v38, v38, v3
    v_add_u32 v39, 13312, v38
    s_lshl_b32 s73, s29, 7
    s_mul_i32 s22, s33, 28672
    s_add_u32 s73, s73, s22
    s_lshl_b32 s90, s33, 11
    s_mov_b32 s12, s56
    s_mov_b32 s13, s57
    s_mov_b32 s14, 1835008
    s_mov_b32 s15, 0x00020000
    s_waitcnt vmcnt(6)
    s_barrier
    s_add_u32 s20, s30, 4
    s_and_b32 s20, s20, 7
    s_lshl_b32 s21, s20, 7
    s_add_u32 m0, s75, 147456
    s_add_u32 s69, s72, s21
    buffer_load_dwordx4 v36, s[8:11], s69 offen lds
    buffer_load_dwordx4 v37, s[8:11], s69 offen offset:1024 lds
    s_add_u32 m0, s74, 73728
    s_add_u32 s68, s71, s21
    buffer_load_dwordx4 v32, s[4:7], s68 offen lds
    buffer_load_dwordx4 v33, s[4:7], s68 offen offset:1024 lds
    buffer_load_dwordx4 v34, s[4:7], s68 offen offset:2048 lds
    buffer_load_dwordx4 v35, s[4:7], s68 offen offset:3072 lds
    ds_read_b128 v[160:163], v16 offset:32768
    ds_read_b128 v[164:167], v16 offset:34816
    ds_read_b128 v[168:171], v17 offset:32768
    ds_read_b128 v[172:175], v17 offset:34816
    v_mov_b32 v28, 0x3f803f80
    v_mov_b32 v29, 0x3f803f80
    v_mov_b32 v30, 0x3f803f80
    v_mov_b32 v31, 0x3f803f80
    v_and_b32 v40, 31, v0
    v_lshlrev_b32 v40, 3, v40
    s_lshl2_add_u32 s78, s27, s33
    s_lshl_b32 s78, s78, 8
    s_add_u32 s78, s78, 4096
    s_waitcnt vmcnt(6)
    s_barrier
    s_add_u32 s20, s30, 5
    s_and_b32 s20, s20, 7
    s_lshl_b32 s21, s20, 7
    s_add_u32 m0, s75, 155648
    s_add_u32 s69, s72, s21
    buffer_load_dwordx4 v36, s[8:11], s69 offen lds
    buffer_load_dwordx4 v37, s[8:11], s69 offen offset:1024 lds
    s_add_u32 m0, s74, 90112
    s_add_u32 s68, s71, s21
    buffer_load_dwordx4 v32, s[4:7], s68 offen lds
    buffer_load_dwordx4 v33, s[4:7], s68 offen offset:1024 lds
    buffer_load_dwordx4 v34, s[4:7], s68 offen offset:2048 lds
    buffer_load_dwordx4 v35, s[4:7], s68 offen offset:3072 lds
    ds_read_b128 v[176:179], v16 offset:49152
    ds_read_b128 v[180:183], v16 offset:51200
    ds_read_b128 v[184:187], v17 offset:49152
    ds_read_b128 v[188:191], v17 offset:51200
    v_lshrrev_b32 v2, 4, v0
    v_bfe_u32 v3, v0, 2, 2
    v_lshl_add_u32 v4, v2, 3, v3
    v_lshlrev_b32 v4, 8, v4
    v_lshl_add_u32 v4, v3, 6, v4
    v_and_b32 v2, 1, v2
    v_lshl_add_u32 v4, v2, 5, v4
    v_and_b32 v3, 3, v0
    v_lshl_add_u32 v4, v3, 3, v4
    v_add_u32 v8, 8192, v4
    s_lshl_b32 s20, s33, 6
    v_xor_b32 v8, s20, v8
    v_xor_b32 v9, 32, v8
    v_xor_b32 v10, 64, v8
    v_xor_b32 v11, 96, v8
    v_xor_b32 v12, 128, v8
    v_xor_b32 v13, 160, v8
    v_xor_b32 v14, 192, v8
    v_xor_b32 v15, 224, v8
    s_waitcnt vmcnt(6)
    s_barrier
    s_add_u32 s20, s30, 6
    s_and_b32 s20, s20, 7
    s_lshl_b32 s21, s20, 7
    s_add_u32 m0, s75, 139264
    s_add_u32 s69, s72, s21
    buffer_load_dwordx4 v36, s[8:11], s69 offen lds
    buffer_load_dwordx4 v37, s[8:11], s69 offen offset:1024 lds
    s_add_u32 m0, s74, 106496
    s_add_u32 s68, s71, s21
    buffer_load_dwordx4 v32, s[4:7], s68 offen lds
    buffer_load_dwordx4 v33, s[4:7], s68 offen offset:1024 lds
    buffer_load_dwordx4 v34, s[4:7], s68 offen offset:2048 lds
    buffer_load_dwordx4 v35, s[4:7], s68 offen offset:3072 lds
    v_add_u32 v16, 65536, v16
    v_add_u32 v17, 65536, v17
    ds_read_b128 v[192:195], v16 offset:0
    ds_read_b128 v[196:199], v16 offset:2048
    ds_read_b128 v[200:203], v17 offset:0
    ds_read_b128 v[204:207], v17 offset:2048
    s_waitcnt vmcnt(6)
    s_waitcnt lgkmcnt(0)
    s_barrier
    buffer_load_dwordx2 v[42:43], v40, s[16:19], s78 offen sc1
    s_add_u32 s20, s30, 7
    s_and_b32 s20, s20, 7
    s_lshl_b32 s21, s20, 7
    s_add_u32 m0, s75, 147456
    s_add_u32 s69, s72, s21
    buffer_load_dwordx4 v36, s[8:11], s69 offen lds
    buffer_load_dwordx4 v37, s[8:11], s69 offen offset:1024 lds
    s_add_u32 m0, s74, 122880
    s_add_u32 s68, s71, s21
    buffer_load_dwordx4 v32, s[4:7], s68 offen lds
    buffer_load_dwordx4 v33, s[4:7], s68 offen offset:1024 lds
    buffer_load_dwordx4 v34, s[4:7], s68 offen offset:2048 lds
    buffer_load_dwordx4 v35, s[4:7], s68 offen offset:3072 lds
    ds_read_b128 v[208:211], v16 offset:16384
    ds_read_b128 v[212:215], v16 offset:18432
    ds_read_b128 v[216:219], v17 offset:16384
    ds_read_b128 v[220:223], v17 offset:18432
    s_add_u32 s20, s30, 0
    s_and_b32 s20, s20, 7
    s_mul_i32 s20, s20, 229376
    s_add_u32 m0, s90, 8192
    s_add_u32 s70, s73, s20
    buffer_load_dwordx4 v38, s[12:15], s70 offen lds
    buffer_load_dwordx4 v39, s[12:15], s70 offen offset:1024 lds
    s_add_u32 m0, s90, 16384
    s_add_u32 s70, s70, 114688
    buffer_load_dwordx4 v38, s[12:15], s70 offen lds
    buffer_load_dwordx4 v39, s[12:15], s70 offen offset:1024 lds
    s_and_b32 s20, s33, 1
    s_cmp_eq_u32 s20, 0
    s_cselect_b32 s8, s60, s60
    s_cselect_b32 s9, s61, s61
    s_cselect_b32 s22, s46, s48
    s_cselect_b32 s23, s47, s49
    s_mov_b32 s10, 1835008
    s_lshl1_add_u32 s20, s2, s20
    s_cmp_lt_u32 s33, 2
    s_cselect_b32 s8, s8, s22
    s_cselect_b32 s9, s9, s23
    s_cselect_b32 s10, s10, 524288
    s_cselect_b32 s20, s20, s2
    s_cselect_b32 s22, 28, 16
    s_mul_i32 s21, s22, s20
    v_cmp_gt_u32 vcc, s22, v0
    v_add_lshl_u32 v44, v0, s21, 7
    v_mov_b32 v45, 0x40000000
    v_cndmask_b32 v44, v45, v44, vcc
    s_waitcnt vmcnt(11)
    s_barrier
    ds_read_b128 v[224:227], v16 offset:32768
    ds_read_b128 v[228:231], v16 offset:34816
    ds_read_b128 v[232:235], v17 offset:32768
    ds_read_b128 v[236:239], v17 offset:34816
    s_add_u32 s20, s30, 1
    s_and_b32 s20, s20, 7
    s_mul_i32 s20, s20, 229376
    s_add_u32 m0, s90, 24576
    s_add_u32 s70, s73, s20
    buffer_load_dwordx4 v38, s[12:15], s70 offen lds
    buffer_load_dwordx4 v39, s[12:15], s70 offen offset:1024 lds
    s_add_u32 m0, s90, 32768
    s_add_u32 s70, s70, 114688
    buffer_load_dwordx4 v38, s[12:15], s70 offen lds
    buffer_load_dwordx4 v39, s[12:15], s70 offen offset:1024 lds
    v_and_b32 v45, 1, v0
    v_xor_b32 v45, 0, v45
    v_lshl_or_b32 v45, v45, 30, v44
    buffer_load_dword v19, v45, s[8:11], 0 offen
    s_waitcnt vmcnt(15)
L_chk_7:
    v_cmp_ne_u32 vcc, v43, v1
    s_nop 4
    s_cbranch_vccnz L_retry_9
L_ok_8:
    v_and_b32 v2, s76, v42
    v_rcp_f32 v2, v2
    v_lshrrev_b32 v3, 1, v40
    s_lshl_b32 s20, s33, 7
    s_add_u32 s20, s20, 0
    v_add_u32 v3, s20, v3
    v_lshlrev_b32 v4, 16, v42
    ds_write_b32 v3, v42 offset:1024
    ds_write_b32 v3, v2 offset:512
    ds_write_b32 v3, v4
    s_waitcnt vmcnt(9)
    s_waitcnt lgkmcnt(0)
    s_barrier
    ds_read_b128 v[240:243], v16 offset:49152
    ds_read_b128 v[244:247], v16 offset:51200
    ds_read_b128 v[248:251], v17 offset:49152
    ds_read_b128 v[252:255], v17 offset:51200
    s_add_u32 s20, s30, 2
    s_and_b32 s20, s20, 7
    s_mul_i32 s20, s20, 229376
    s_add_u32 m0, s90, 40960
    s_add_u32 s70, s73, s20
    buffer_load_dwordx4 v38, s[12:15], s70 offen lds
    buffer_load_dwordx4 v39, s[12:15], s70 offen offset:1024 lds
    s_add_u32 m0, s90, 49152
    s_add_u32 s70, s70, 114688
    buffer_load_dwordx4 v38, s[12:15], s70 offen lds
    buffer_load_dwordx4 v39, s[12:15], s70 offen offset:1024 lds
    v_and_b32 v45, 1, v0
    v_xor_b32 v45, 1, v45
    v_lshl_or_b32 v45, v45, 30, v44
    buffer_load_dword v19, v45, s[8:11], 0 offen
    v_bfe_u32 v2, v0, 2, 2
    v_and_b32 v3, 3, v0
    v_lshl_add_u32 v2, v2, 4, v3
    s_and_b32 s21, s33, 1
    s_lshl3_add_u32 s20, s89, s21
    s_lshl_b32 s20, s20, 5
    s_add_u32 s20, s20, 0
    v_lshl_add_u32 v2, v2, 2, s20
    ds_read_b32 v23, v2 offset:1024
    ds_read_b32 v25, v2 offset:1040
    ds_read_b32 v20, v2 offset:512
    ds_read_b32 v21, v2 offset:528
    v_and_b32 v18, 15, v0
    v_lshlrev_b32 v18, 3, v18
    s_lshl_b32 s20, s33, 8
    s_add_u32 s20, s20, 2048
    v_add_u32 v18, s20, v18
    v_cmp_gt_u32 vcc, 16, v0
    s_mov_b32 s22, 0x01000100
    s_waitcnt lgkmcnt(0)
    v_perm_b32 v22, v23, v23, s22
    v_xor_b32 v22, 0x80008000, v22
    v_lshrrev_b32 v23, 16, v23
    v_cndmask_b32 v22, 0, v22, vcc
    v_cndmask_b32 v23, 0, v23, vcc
    v_mul_f32 v20, 1069066811, v20
    v_perm_b32 v24, v25, v25, s22
    v_xor_b32 v24, 0x80008000, v24
    v_lshrrev_b32 v25, 16, v25
    v_cndmask_b32 v24, 0, v24, vcc
    v_cndmask_b32 v25, 0, v25, vcc
    v_mul_f32 v21, 1069066811, v21
    s_waitcnt vmcnt(10)
    s_waitcnt lgkmcnt(0)
    s_barrier
    ds_read_b64_tr_b16 v[32:33], v8 offset:0
    ds_read_b64_tr_b16 v[34:35], v8 offset:1024
    ds_read_b64_tr_b16 v[36:37], v9 offset:0
    ds_read_b64_tr_b16 v[38:39], v9 offset:1024
    ds_read_b64_tr_b16 v[40:41], v10 offset:0
    ds_read_b64_tr_b16 v[42:43], v10 offset:1024
    ds_read_b64_tr_b16 v[44:45], v11 offset:0
    ds_read_b64_tr_b16 v[46:47], v11 offset:1024
    s_waitcnt lgkmcnt(6)
    v_mfma_f32_16x16x32_bf16 v[64:67], v[32:35], v[128:131], 0
    ds_read_b64_tr_b16 v[48:49], v12 offset:0
    v_mfma_f32_16x16x32_bf16 v[68:71], v[32:35], v[132:135], 0
    ds_read_b64_tr_b16 v[50:51], v12 offset:1024
    v_mfma_f32_16x16x32_bf16 v[56:59], v[28:31], v[32:35], 0
    s_waitcnt lgkmcnt(6)
    v_mfma_f32_16x16x32_bf16 v[72:75], v[36:39], v[128:131], 0
    ds_read_b64_tr_b16 v[52:53], v13 offset:0
    v_mfma_f32_16x16x32_bf16 v[76:79], v[36:39], v[132:135], 0
    ds_read_b64_tr_b16 v[54:55], v13 offset:1024
    v_mfma_f32_16x16x32_bf16 v[60:63], v[28:31], v[36:39], 0
    s_waitcnt lgkmcnt(6)
    v_mfma_f32_16x16x32_bf16 v[80:83], v[40:43], v[128:131], 0
    ds_read_b64_tr_b16 v[32:33], v14 offset:0
    v_mfma_f32_16x16x32_bf16 v[84:87], v[40:43], v[132:135], 0
    ds_read_b64_tr_b16 v[34:35], v14 offset:1024
    s_waitcnt lgkmcnt(6)
    v_mfma_f32_16x16x32_bf16 v[88:91], v[44:47], v[128:131], 0
    ds_read_b64_tr_b16 v[36:37], v15 offset:0
    v_mfma_f32_16x16x32_bf16 v[92:95], v[44:47], v[132:135], 0
    ds_read_b64_tr_b16 v[38:39], v15 offset:1024
    s_waitcnt lgkmcnt(6)
    v_mfma_f32_16x16x32_bf16 v[96:99], v[48:51], v[128:131], 0
    ds_read_b64_tr_b16 v[40:41], v8 offset:8192
    v_mfma_f32_16x16x32_bf16 v[100:103], v[48:51], v[132:135], 0
    ds_read_b64_tr_b16 v[42:43], v8 offset:9216
    s_waitcnt lgkmcnt(6)
    v_mfma_f32_16x16x32_bf16 v[104:107], v[52:55], v[128:131], 0
    ds_read_b64_tr_b16 v[44:45], v9 offset:8192
    v_mfma_f32_16x16x32_bf16 v[108:111], v[52:55], v[132:135], 0
    ds_read_b64_tr_b16 v[46:47], v9 offset:9216
    s_waitcnt lgkmcnt(6)
    v_mfma_f32_16x16x32_bf16 v[112:115], v[32:35], v[128:131], 0
    ds_read_b64_tr_b16 v[48:49], v10 offset:8192
    v_mfma_f32_16x16x32_bf16 v[116:119], v[32:35], v[132:135], 0
    ds_read_b64_tr_b16 v[50:51], v10 offset:9216
    s_waitcnt lgkmcnt(6)
    v_mfma_f32_16x16x32_bf16 v[120:123], v[36:39], v[128:131], 0
    ds_read_b64_tr_b16 v[52:53], v11 offset:8192
    v_mfma_f32_16x16x32_bf16 v[124:127], v[36:39], v[132:135], 0
    ds_read_b64_tr_b16 v[54:55], v11 offset:9216
    s_waitcnt lgkmcnt(6)
    v_mfma_f32_16x16x32_bf16 v[64:67], v[40:43], v[136:139], v[64:67]
    ds_read_b64_tr_b16 v[32:33], v12 offset:8192
    v_mfma_f32_16x16x32_bf16 v[68:71], v[40:43], v[140:143], v[68:71]
    ds_read_b64_tr_b16 v[34:35], v12 offset:9216
    v_mfma_f32_16x16x32_bf16 v[56:59], v[28:31], v[40:43], v[56:59]
    s_waitcnt lgkmcnt(6)
    v_mfma_f32_16x16x32_bf16 v[72:75], v[44:47], v[136:139], v[72:75]
    ds_read_b64_tr_b16 v[36:37], v13 offset:8192
    v_mfma_f32_16x16x32_bf16 v[76:79], v[44:47], v[140:143], v[76:79]
    ds_read_b64_tr_b16 v[38:39], v13 offset:9216
    v_mfma_f32_16x16x32_bf16 v[60:63], v[28:31], v[44:47], v[60:63]
    s_waitcnt lgkmcnt(6)
    v_mfma_f32_16x16x32_bf16 v[80:83], v[48:51], v[136:139], v[80:83]
    ds_read_b64_tr_b16 v[40:41], v14 offset:8192
    v_mfma_f32_16x16x32_bf16 v[84:87], v[48:51], v[140:143], v[84:87]
    ds_read_b64_tr_b16 v[42:43], v14 offset:9216
    s_waitcnt lgkmcnt(6)
    v_mfma_f32_16x16x32_bf16 v[88:91], v[52:55], v[136:139], v[88:91]
    ds_read_b64_tr_b16 v[44:45], v15 offset:8192
    v_mfma_f32_16x16x32_bf16 v[92:95], v[52:55], v[140:143], v[92:95]
    ds_read_b64_tr_b16 v[46:47], v15 offset:9216
    s_waitcnt lgkmcnt(6)
    v_mfma_f32_16x16x32_bf16 v[96:99], v[32:35], v[136:139], v[96:99]
    s_waitcnt vmcnt(6)
    s_barrier
    ds_read_b64_tr_b16 v[48:49], v8 offset:16384
    v_mfma_f32_16x16x32_bf16 v[100:103], v[32:35], v[140:143], v[100:103]
    ds_read_b64_tr_b16 v[50:51], v8 offset:17408
    s_waitcnt lgkmcnt(6)
    v_mfma_f32_16x16x32_bf16 v[104:107], v[36:39], v[136:139], v[104:107]
    ds_read_b64_tr_b16 v[52:53], v9 offset:16384
    v_mfma_f32_16x16x32_bf16 v[108:111], v[36:39], v[140:143], v[108:111]
    ds_read_b64_tr_b16 v[54:55], v9 offset:17408
    s_waitcnt lgkmcnt(6)
    v_mfma_f32_16x16x32_bf16 v[112:115], v[40:43], v[136:139], v[112:115]
    ds_read_b64_tr_b16 v[32:33], v10 offset:16384
    v_mfma_f32_16x16x32_bf16 v[116:119], v[40:43], v[140:143], v[116:119]
    ds_read_b64_tr_b16 v[34:35], v10 offset:17408
    s_waitcnt lgkmcnt(6)
    v_mfma_f32_16x16x32_bf16 v[120:123], v[44:47], v[136:139], v[120:123]
    ds_read_b64_tr_b16 v[36:37], v11 offset:16384
    v_mfma_f32_16x16x32_bf16 v[124:127], v[44:47], v[140:143], v[124:127]
    ds_read_b64_tr_b16 v[38:39], v11 offset:17408
    s_waitcnt lgkmcnt(6)
    v_mfma_f32_16x16x32_bf16 v[64:67], v[48:51], v[144:147], v[64:67]
    ds_read_b64_tr_b16 v[40:41], v12 offset:16384
    v_mfma_f32_16x16x32_bf16 v[68:71], v[48:51], v[148:151], v[68:71]
    ds_read_b64_tr_b16 v[42:43], v12 offset:17408
    v_mfma_f32_16x16x32_bf16 v[56:59], v[28:31], v[48:51], v[56:59]
    s_waitcnt lgkmcnt(6)
    v_mfma_f32_16x16x32_bf16 v[72:75], v[52:55], v[144:147], v[72:75]
    ds_read_b64_tr_b16 v[44:45], v13 offset:16384
    v_mfma_f32_16x16x32_bf16 v[76:79], v[52:55], v[148:151], v[76:79]
    ds_read_b64_tr_b16 v[46:47], v13 offset:17408
    v_mfma_f32_16x16x32_bf16 v[60:63], v[28:31], v[52:55], v[60:63]
    s_waitcnt lgkmcnt(6)
    v_mfma_f32_16x16x32_bf16 v[80:83], v[32:35], v[144:147], v[80:83]
    ds_read_b64_tr_b16 v[48:49], v14 offset:16384
    v_mfma_f32_16x16x32_bf16 v[84:87], v[32:35], v[148:151], v[84:87]
    ds_read_b64_tr_b16 v[50:51], v14 offset:17408
    s_waitcnt lgkmcnt(6)
    v_mfma_f32_16x16x32_bf16 v[88:91], v[36:39], v[144:147], v[88:91]
    ds_read_b64_tr_b16 v[52:53], v15 offset:16384
    v_mfma_f32_16x16x32_bf16 v[92:95], v[36:39], v[148:151], v[92:95]
    ds_read_b64_tr_b16 v[54:55], v15 offset:17408
    s_waitcnt lgkmcnt(6)
    v_mfma_f32_16x16x32_bf16 v[96:99], v[40:43], v[144:147], v[96:99]
    ds_read_b64_tr_b16 v[32:33], v8 offset:24576
    v_mfma_f32_16x16x32_bf16 v[100:103], v[40:43], v[148:151], v[100:103]
    ds_read_b64_tr_b16 v[34:35], v8 offset:25600
    s_waitcnt lgkmcnt(6)
    v_mfma_f32_16x16x32_bf16 v[104:107], v[44:47], v[144:147], v[104:107]
    ds_read_b64_tr_b16 v[36:37], v9 offset:24576
    v_mfma_f32_16x16x32_bf16 v[108:111], v[44:47], v[148:151], v[108:111]
    ds_read_b64_tr_b16 v[38:39], v9 offset:25600
    s_waitcnt lgkmcnt(6)
    v_mfma_f32_16x16x32_bf16 v[112:115], v[48:51], v[144:147], v[112:115]
    ds_read_b64_tr_b16 v[40:41], v10 offset:24576
    v_mfma_f32_16x16x32_bf16 v[116:119], v[48:51], v[148:151], v[116:119]
    ds_read_b64_tr_b16 v[42:43], v10 offset:25600
    s_waitcnt lgkmcnt(6)
    v_mfma_f32_16x16x32_bf16 v[120:123], v[52:55], v[144:147], v[120:123]
    ds_read_b64_tr_b16 v[44:45], v11 offset:24576
    v_mfma_f32_16x16x32_bf16 v[124:127], v[52:55], v[148:151], v[124:127]
    ds_read_b64_tr_b16 v[46:47], v11 offset:25600
    s_waitcnt lgkmcnt(6)
    v_mfma_f32_16x16x32_bf16 v[64:67], v[32:35], v[152:155], v[64:67]
    ds_read_b64_tr_b16 v[48:49], v12 offset:24576
    v_mfma_f32_16x16x32_bf16 v[68:71], v[32:35], v[156:159], v[68:71]
    ds_read_b64_tr_b16 v[50:51], v12 offset:25600
    v_mfma_f32_16x16x32_bf16 v[56:59], v[28:31], v[32:35], v[56:59]
    s_waitcnt lgkmcnt(6)
    v_mfma_f32_16x16x32_bf16 v[72:75], v[36:39], v[152:155], v[72:75]
    ds_read_b64_tr_b16 v[52:53], v13 offset:24576
    v_mfma_f32_16x16x32_bf16 v[76:79], v[36:39], v[156:159], v[76:79]
    ds_read_b64_tr_b16 v[54:55], v13 offset:25600
    v_mfma_f32_16x16x32_bf16 v[60:63], v[28:31], v[36:39], v[60:63]
    s_waitcnt lgkmcnt(6)
    v_mfma_f32_16x16x32_bf16 v[80:83], v[40:43], v[152:155], v[80:83]
    ds_read_b64_tr_b16 v[32:33], v14 offset:24576
    v_mfma_f32_16x16x32_bf16 v[84:87], v[40:43], v[156:159], v[84:87]
    ds_read_b64_tr_b16 v[34:35], v14 offset:25600
    s_waitcnt lgkmcnt(6)
    v_mfma_f32_16x16x32_bf16 v[88:91], v[44:47], v[152:155], v[88:91]
    ds_read_b64_tr_b16 v[36:37], v15 offset:24576
    v_mfma_f32_16x16x32_bf16 v[92:95], v[44:47], v[156:159], v[92:95]
    ds_read_b64_tr_b16 v[38:39], v15 offset:25600
    s_waitcnt lgkmcnt(6)
    v_mfma_f32_16x16x32_bf16 v[96:99], v[48:51], v[152:155], v[96:99]
    s_waitcnt vmcnt(1)
    s_barrier
    ds_read_b64_tr_b16 v[40:41], v8 offset:32768
    v_mfma_f32_16x16x32_bf16 v[100:103], v[48:51], v[156:159], v[100:103]
    ds_read_b64_tr_b16 v[42:43], v8 offset:33792
    s_waitcnt lgkmcnt(6)
    v_mfma_f32_16x16x32_bf16 v[104:107], v[52:55], v[152:155], v[104:107]
    ds_read_b64_tr_b16 v[44:45], v9 offset:32768
    v_mfma_f32_16x16x32_bf16 v[108:111], v[52:55], v[156:159], v[108:111]
    ds_read_b64_tr_b16 v[46:47], v9 offset:33792
    s_waitcnt lgkmcnt(6)
    v_mfma_f32_16x16x32_bf16 v[112:115], v[32:35], v[152:155], v[112:115]
    ds_read_b64_tr_b16 v[48:49], v10 offset:32768
    v_mfma_f32_16x16x32_bf16 v[116:119], v[32:35], v[156:159], v[116:119]
    ds_read_b64_tr_b16 v[50:51], v10 offset:33792
    s_waitcnt lgkmcnt(6)
    v_mfma_f32_16x16x32_bf16 v[120:123], v[36:39], v[152:155], v[120:123]
    ds_read_b64_tr_b16 v[52:53], v11 offset:32768
    v_mfma_f32_16x16x32_bf16 v[124:127], v[36:39], v[156:159], v[124:127]
    ds_read_b64_tr_b16 v[54:55], v11 offset:33792
    s_waitcnt lgkmcnt(6)
    v_mfma_f32_16x16x32_bf16 v[64:67], v[40:43], v[160:163], v[64:67]
    ds_read_b64_tr_b16 v[32:33], v12 offset:32768
    v_mfma_f32_16x16x32_bf16 v[68:71], v[40:43], v[164:167], v[68:71]
    ds_read_b64_tr_b16 v[34:35], v12 offset:33792
    v_mfma_f32_16x16x32_bf16 v[56:59], v[28:31], v[40:43], v[56:59]
    s_waitcnt lgkmcnt(6)
    v_mfma_f32_16x16x32_bf16 v[72:75], v[44:47], v[160:163], v[72:75]
    ds_read_b64_tr_b16 v[36:37], v13 offset:32768
    v_mfma_f32_16x16x32_bf16 v[76:79], v[44:47], v[164:167], v[76:79]
    ds_read_b64_tr_b16 v[38:39], v13 offset:33792
    v_mfma_f32_16x16x32_bf16 v[60:63], v[28:31], v[44:47], v[60:63]
    s_waitcnt lgkmcnt(6)
    v_mfma_f32_16x16x32_bf16 v[80:83], v[48:51], v[160:163], v[80:83]
    ds_read_b64_tr_b16 v[40:41], v14 offset:32768
    v_mfma_f32_16x16x32_bf16 v[84:87], v[48:51], v[164:167], v[84:87]
    ds_read_b64_tr_b16 v[42:43], v14 offset:33792
    s_waitcnt lgkmcnt(6)
    v_mfma_f32_16x16x32_bf16 v[88:91], v[52:55], v[160:163], v[88:91]
    ds_read_b64_tr_b16 v[44:45], v15 offset:32768
    v_mfma_f32_16x16x32_bf16 v[92:95], v[52:55], v[164:167], v[92:95]
    ds_read_b64_tr_b16 v[46:47], v15 offset:33792
    s_waitcnt lgkmcnt(6)
    v_mfma_f32_16x16x32_bf16 v[96:99], v[32:35], v[160:163], v[96:99]
    ds_read_b64_tr_b16 v[48:49], v8 offset:40960
    v_mfma_f32_16x16x32_bf16 v[100:103], v[32:35], v[164:167], v[100:103]
    ds_read_b64_tr_b16 v[50:51], v8 offset:41984
    s_waitcnt lgkmcnt(6)
    v_mfma_f32_16x16x32_bf16 v[104:107], v[36:39], v[160:163], v[104:107]
    ds_read_b64_tr_b16 v[52:53], v9 offset:40960
    v_mfma_f32_16x16x32_bf16 v[108:111], v[36:39], v[164:167], v[108:111]
    ds_read_b64_tr_b16 v[54:55], v9 offset:41984
    s_waitcnt lgkmcnt(6)
    v_mfma_f32_16x16x32_bf16 v[112:115], v[40:43], v[160:163], v[112:115]
    ds_read_b64_tr_b16 v[32:33], v10 offset:40960
    v_mfma_f32_16x16x32_bf16 v[116:119], v[40:43], v[164:167], v[116:119]
    ds_read_b64_tr_b16 v[34:35], v10 offset:41984
    s_waitcnt lgkmcnt(6)
    v_mfma_f32_16x16x32_bf16 v[120:123], v[44:47], v[160:163], v[120:123]
    ds_read_b64_tr_b16 v[36:37], v11 offset:40960
    v_mfma_f32_16x16x32_bf16 v[124:127], v[44:47], v[164:167], v[124:127]
    ds_read_b64_tr_b16 v[38:39], v11 offset:41984
    s_waitcnt lgkmcnt(6)
    v_mfma_f32_16x16x32_bf16 v[64:67], v[48:51], v[168:171], v[64:67]
    ds_read_b64_tr_b16 v[40:41], v12 offset:40960
    v_mfma_f32_16x16x32_bf16 v[68:71], v[48:51], v[172:175], v[68:71]
    ds_read_b64_tr_b16 v[42:43], v12 offset:41984
    v_mfma_f32_16x16x32_bf16 v[56:59], v[28:31], v[48:51], v[56:59]
    s_waitcnt lgkmcnt(6)
    v_mfma_f32_16x16x32_bf16 v[72:75], v[52:55], v[168:171], v[72:75]
    ds_read_b64_tr_b16 v[44:45], v13 offset:40960
    v_mfma_f32_16x16x32_bf16 v[76:79], v[52:55], v[172:175], v[76:79]
    ds_read_b64_tr_b16 v[46:47], v13 offset:41984
    v_mfma_f32_16x16x32_bf16 v[60:63], v[28:31], v[52:55], v[60:63]
    s_waitcnt lgkmcnt(6)
    v_mfma_f32_16x16x32_bf16 v[80:83], v[32:35], v[168:171], v[80:83]
    ds_read_b64_tr_b16 v[48:49], v14 offset:40960
    v_mfma_f32_16x16x32_bf16 v[84:87], v[32:35], v[172:175], v[84:87]
    ds_read_b64_tr_b16 v[50:51], v14 offset:41984
    s_waitcnt lgkmcnt(6)
    v_mfma_f32_16x16x32_bf16 v[88:91], v[36:39], v[168:171], v[88:91]
    ds_read_b64_tr_b16 v[52:53], v15 offset:40960
    v_mfma_f32_16x16x32_bf16 v[92:95], v[36:39], v[172:175], v[92:95]
    ds_read_b64_tr_b16 v[54:55], v15 offset:41984
    s_waitcnt lgkmcnt(6)
    v_mfma_f32_16x16x32_bf16 v[96:99], v[40:43], v[168:171], v[96:99]
    s_barrier
    ds_read_b64_tr_b16 v[32:33], v8 offset:49152
    v_mfma_f32_16x16x32_bf16 v[100:103], v[40:43], v[172:175], v[100:103]
    ds_read_b64_tr_b16 v[34:35], v8 offset:50176
    s_waitcnt lgkmcnt(6)
    v_mfma_f32_16x16x32_bf16 v[104:107], v[44:47], v[168:171], v[104:107]
    ds_read_b64_tr_b16 v[36:37], v9 offset:49152
    v_mfma_f32_16x16x32_bf16 v[108:111], v[44:47], v[172:175], v[108:111]
    ds_read_b64_tr_b16 v[38:39], v9 offset:50176
    s_waitcnt lgkmcnt(6)
    v_mfma_f32_16x16x32_bf16 v[112:115], v[48:51], v[168:171], v[112:115]
    ds_read_b64_tr_b16 v[40:41], v10 offset:49152
    v_mfma_f32_16x16x32_bf16 v[116:119], v[48:51], v[172:175], v[116:119]
    ds_read_b64_tr_b16 v[42:43], v10 offset:50176
    s_waitcnt lgkmcnt(6)
    v_mfma_f32_16x16x32_bf16 v[120:123], v[52:55], v[168:171], v[120:123]
    ds_read_b64_tr_b16 v[44:45], v11 offset:49152
    v_mfma_f32_16x16x32_bf16 v[124:127], v[52:55], v[172:175], v[124:127]
    ds_read_b64_tr_b16 v[46:47], v11 offset:50176
    s_waitcnt lgkmcnt(6)
    v_mfma_f32_16x16x32_bf16 v[64:67], v[32:35], v[176:179], v[64:67]
    ds_read_b64_tr_b16 v[48:49], v12 offset:49152
    v_mfma_f32_16x16x32_bf16 v[68:71], v[32:35], v[180:183], v[68:71]
    ds_read_b64_tr_b16 v[50:51], v12 offset:50176
    v_mfma_f32_16x16x32_bf16 v[56:59], v[28:31], v[32:35], v[56:59]
    s_waitcnt lgkmcnt(6)
    v_mfma_f32_16x16x32_bf16 v[72:75], v[36:39], v[176:179], v[72:75]
    ds_read_b64_tr_b16 v[52:53], v13 offset:49152
    v_mfma_f32_16x16x32_bf16 v[76:79], v[36:39], v[180:183], v[76:79]
    ds_read_b64_tr_b16 v[54:55], v13 offset:50176
    v_mfma_f32_16x16x32_bf16 v[60:63], v[28:31], v[36:39], v[60:63]
    s_waitcnt lgkmcnt(6)
    v_mfma_f32_16x16x32_bf16 v[80:83], v[40:43], v[176:179], v[80:83]
    ds_read_b64_tr_b16 v[32:33], v14 offset:49152
    v_mfma_f32_16x16x32_bf16 v[84:87], v[40:43], v[180:183], v[84:87]
    ds_read_b64_tr_b16 v[34:35], v14 offset:50176
    s_waitcnt lgkmcnt(6)
    v_mfma_f32_16x16x32_bf16 v[88:91], v[44:47], v[176:179], v[88:91]
    ds_read_b64_tr_b16 v[36:37], v15 offset:49152
    v_mfma_f32_16x16x32_bf16 v[92:95], v[44:47], v[180:183], v[92:95]
    ds_read_b64_tr_b16 v[38:39], v15 offset:50176
    s_waitcnt lgkmcnt(6)
    v_mfma_f32_16x16x32_bf16 v[96:99], v[48:51], v[176:179], v[96:99]
    ds_read_b64_tr_b16 v[40:41], v8 offset:0
    v_mfma_f32_16x16x32_bf16 v[100:103], v[48:51], v[180:183], v[100:103]
    ds_read_b64_tr_b16 v[42:43], v8 offset:1024
    s_waitcnt lgkmcnt(6)
    v_mfma_f32_16x16x32_bf16 v[104:107], v[52:55], v[176:179], v[104:107]
    ds_read_b64_tr_b16 v[44:45], v9 offset:0
    v_mfma_f32_16x16x32_bf16 v[108:111], v[52:55], v[180:183], v[108:111]
    ds_read_b64_tr_b16 v[46:47], v9 offset:1024
    s_waitcnt lgkmcnt(6)
    v_mfma_f32_16x16x32_bf16 v[112:115], v[32:35], v[176:179], v[112:115]
    ds_read_b64_tr_b16 v[48:49], v10 offset:0
    v_mfma_f32_16x16x32_bf16 v[116:119], v[32:35], v[180:183], v[116:119]
    ds_read_b64_tr_b16 v[50:51], v10 offset:1024
    s_waitcnt lgkmcnt(6)
    v_mfma_f32_16x16x32_bf16 v[120:123], v[36:39], v[176:179], v[120:123]
    ds_read_b64_tr_b16 v[52:53], v11 offset:0
    v_mfma_f32_16x16x32_bf16 v[124:127], v[36:39], v[180:183], v[124:127]
    ds_read_b64_tr_b16 v[54:55], v11 offset:1024
    s_waitcnt lgkmcnt(6)
    v_mfma_f32_16x16x32_bf16 v[64:67], v[40:43], v[184:187], v[64:67]
    ds_read_b64_tr_b16 v[32:33], v12 offset:0
    v_mfma_f32_16x16x32_bf16 v[68:71], v[40:43], v[188:191], v[68:71]
    ds_read_b64_tr_b16 v[34:35], v12 offset:1024
    v_mfma_f32_16x16x32_bf16 v[56:59], v[28:31], v[40:43], v[56:59]
    s_waitcnt lgkmcnt(6)
    v_mfma_f32_16x16x32_bf16 v[72:75], v[44:47], v[184:187], v[72:75]
    ds_read_b64_tr_b16 v[36:37], v13 offset:0
    v_mfma_f32_16x16x32_bf16 v[76:79], v[44:47], v[188:191], v[76:79]
    ds_read_b64_tr_b16 v[38:39], v13 offset:1024
    v_mfma_f32_16x16x32_bf16 v[60:63], v[28:31], v[44:47], v[60:63]
    s_waitcnt lgkmcnt(6)
    v_mfma_f32_16x16x32_bf16 v[80:83], v[48:51], v[184:187], v[80:83]
    ds_read_b64_tr_b16 v[40:41], v14 offset:0
    v_mfma_f32_16x16x32_bf16 v[84:87], v[48:51], v[188:191], v[84:87]
    ds_read_b64_tr_b16 v[42:43], v14 offset:1024
    s_waitcnt lgkmcnt(6)
    v_mfma_f32_16x16x32_bf16 v[88:91], v[52:55], v[184:187], v[88:91]
    ds_read_b64_tr_b16 v[44:45], v15 offset:0
    v_mfma_f32_16x16x32_bf16 v[92:95], v[52:55], v[188:191], v[92:95]
    ds_read_b64_tr_b16 v[46:47], v15 offset:1024
    s_waitcnt lgkmcnt(6)
    v_mfma_f32_16x16x32_bf16 v[96:99], v[32:35], v[184:187], v[96:99]
    s_barrier
    ds_read_b64_tr_b16 v[48:49], v8 offset:8192
    v_mfma_f32_16x16x32_bf16 v[100:103], v[32:35], v[188:191], v[100:103]
    ds_read_b64_tr_b16 v[50:51], v8 offset:9216
    s_waitcnt lgkmcnt(6)
    v_mfma_f32_16x16x32_bf16 v[104:107], v[36:39], v[184:187], v[104:107]
    ds_read_b64_tr_b16 v[52:53], v9 offset:8192
    v_mfma_f32_16x16x32_bf16 v[108:111], v[36:39], v[188:191], v[108:111]
    ds_read_b64_tr_b16 v[54:55], v9 offset:9216
    s_waitcnt lgkmcnt(6)
    v_mfma_f32_16x16x32_bf16 v[112:115], v[40:43], v[184:187], v[112:115]
    ds_read_b64_tr_b16 v[32:33], v10 offset:8192
    v_mfma_f32_16x16x32_bf16 v[116:119], v[40:43], v[188:191], v[116:119]
    ds_read_b64_tr_b16 v[34:35], v10 offset:9216
    s_waitcnt lgkmcnt(6)
    v_mfma_f32_16x16x32_bf16 v[120:123], v[44:47], v[184:187], v[120:123]
    ds_read_b64_tr_b16 v[36:37], v11 offset:8192
    v_mfma_f32_16x16x32_bf16 v[124:127], v[44:47], v[188:191], v[124:127]
    ds_read_b64_tr_b16 v[38:39], v11 offset:9216
    s_waitcnt lgkmcnt(6)
    v_mfma_f32_16x16x32_bf16 v[64:67], v[48:51], v[192:195], v[64:67]
    ds_read_b64_tr_b16 v[40:41], v12 offset:8192
    v_mfma_f32_16x16x32_bf16 v[68:71], v[48:51], v[196:199], v[68:71]
    ds_read_b64_tr_b16 v[42:43], v12 offset:9216
    v_mfma_f32_16x16x32_bf16 v[56:59], v[28:31], v[48:51], v[56:59]
    s_waitcnt lgkmcnt(6)
    v_mfma_f32_16x16x32_bf16 v[72:75], v[52:55], v[192:195], v[72:75]
    ds_read_b64_tr_b16 v[44:45], v13 offset:8192
    v_mfma_f32_16x16x32_bf16 v[76:79], v[52:55], v[196:199], v[76:79]
    ds_read_b64_tr_b16 v[46:47], v13 offset:9216
    v_mfma_f32_16x16x32_bf16 v[60:63], v[28:31], v[52:55], v[60:63]
    s_waitcnt lgkmcnt(6)
    v_mfma_f32_16x16x32_bf16 v[80:83], v[32:35], v[192:195], v[80:83]
    ds_read_b64_tr_b16 v[48:49], v14 offset:8192
    v_mfma_f32_16x16x32_bf16 v[84:87], v[32:35], v[196:199], v[84:87]
    ds_read_b64_tr_b16 v[50:51], v14 offset:9216
    s_waitcnt lgkmcnt(6)
    v_mfma_f32_16x16x32_bf16 v[88:91], v[36:39], v[192:195], v[88:91]
    ds_read_b64_tr_b16 v[52:53], v15 offset:8192
    v_mfma_f32_16x16x32_bf16 v[92:95], v[36:39], v[196:199], v[92:95]
    ds_read_b64_tr_b16 v[54:55], v15 offset:9216
    s_waitcnt lgkmcnt(6)
    v_mfma_f32_16x16x32_bf16 v[96:99], v[40:43], v[192:195], v[96:99]
    ds_read_b64_tr_b16 v[32:33], v8 offset:16384
    v_mfma_f32_16x16x32_bf16 v[100:103], v[40:43], v[196:199], v[100:103]
    ds_read_b64_tr_b16 v[34:35], v8 offset:17408
    s_waitcnt lgkmcnt(6)
    v_mfma_f32_16x16x32_bf16 v[104:107], v[44:47], v[192:195], v[104:107]
    ds_read_b64_tr_b16 v[36:37], v9 offset:16384
    v_mfma_f32_16x16x32_bf16 v[108:111], v[44:47], v[196:199], v[108:111]
    ds_read_b64_tr_b16 v[38:39], v9 offset:17408
    s_waitcnt lgkmcnt(6)
    v_mfma_f32_16x16x32_bf16 v[112:115], v[48:51], v[192:195], v[112:115]
    ds_read_b64_tr_b16 v[40:41], v10 offset:16384
    v_mfma_f32_16x16x32_bf16 v[116:119], v[48:51], v[196:199], v[116:119]
    ds_read_b64_tr_b16 v[42:43], v10 offset:17408
    s_waitcnt lgkmcnt(6)
    v_mfma_f32_16x16x32_bf16 v[120:123], v[52:55], v[192:195], v[120:123]
    ds_read_b64_tr_b16 v[44:45], v11 offset:16384
    v_mfma_f32_16x16x32_bf16 v[124:127], v[52:55], v[196:199], v[124:127]
    ds_read_b64_tr_b16 v[46:47], v11 offset:17408
    s_waitcnt lgkmcnt(6)
    v_mfma_f32_16x16x32_bf16 v[64:67], v[32:35], v[200:203], v[64:67]
    ds_read_b64_tr_b16 v[48:49], v12 offset:16384
    v_mfma_f32_16x16x32_bf16 v[68:71], v[32:35], v[204:207], v[68:71]
    ds_read_b64_tr_b16 v[50:51], v12 offset:17408
    v_mfma_f32_16x16x32_bf16 v[56:59], v[28:31], v[32:35], v[56:59]
    s_waitcnt lgkmcnt(6)
    v_mfma_f32_16x16x32_bf16 v[72:75], v[36:39], v[200:203], v[72:75]
    ds_read_b64_tr_b16 v[52:53], v13 offset:16384
    v_mfma_f32_16x16x32_bf16 v[76:79], v[36:39], v[204:207], v[76:79]
    ds_read_b64_tr_b16 v[54:55], v13 offset:17408
    v_mfma_f32_16x16x32_bf16 v[60:63], v[28:31], v[36:39], v[60:63]
    s_waitcnt lgkmcnt(6)
    v_mfma_f32_16x16x32_bf16 v[80:83], v[40:43], v[200:203], v[80:83]
    ds_read_b64_tr_b16 v[32:33], v14 offset:16384
    v_mfma_f32_16x16x32_bf16 v[84:87], v[40:43], v[204:207], v[84:87]
    ds_read_b64_tr_b16 v[34:35], v14 offset:17408
    s_waitcnt lgkmcnt(6)
    v_mfma_f32_16x16x32_bf16 v[88:91], v[44:47], v[200:203], v[88:91]
    ds_read_b64_tr_b16 v[36:37], v15 offset:16384
    v_mfma_f32_16x16x32_bf16 v[92:95], v[44:47], v[204:207], v[92:95]
    ds_read_b64_tr_b16 v[38:39], v15 offset:17408
    s_waitcnt lgkmcnt(6)
    v_mfma_f32_16x16x32_bf16 v[96:99], v[48:51], v[200:203], v[96:99]
    s_barrier
    ds_read_b64_tr_b16 v[40:41], v8 offset:24576
    v_mfma_f32_16x16x32_bf16 v[100:103], v[48:51], v[204:207], v[100:103]
    ds_read_b64_tr_b16 v[42:43], v8 offset:25600
    s_waitcnt lgkmcnt(6)
    v_mfma_f32_16x16x32_bf16 v[104:107], v[52:55], v[200:203], v[104:107]
    ds_read_b64_tr_b16 v[44:45], v9 offset:24576
    v_mfma_f32_16x16x32_bf16 v[108:111], v[52:55], v[204:207], v[108:111]
    ds_read_b64_tr_b16 v[46:47], v9 offset:25600
    s_waitcnt lgkmcnt(6)
    v_mfma_f32_16x16x32_bf16 v[112:115], v[32:35], v[200:203], v[112:115]
    ds_read_b64_tr_b16 v[48:49], v10 offset:24576
    v_mfma_f32_16x16x32_bf16 v[116:119], v[32:35], v[204:207], v[116:119]
    ds_read_b64_tr_b16 v[50:51], v10 offset:25600
    s_waitcnt lgkmcnt(6)
    v_mfma_f32_16x16x32_bf16 v[120:123], v[36:39], v[200:203], v[120:123]
    ds_read_b64_tr_b16 v[52:53], v11 offset:24576
    v_mfma_f32_16x16x32_bf16 v[124:127], v[36:39], v[204:207], v[124:127]
    ds_read_b64_tr_b16 v[54:55], v11 offset:25600
    s_waitcnt lgkmcnt(6)
    v_mfma_f32_16x16x32_bf16 v[64:67], v[40:43], v[208:211], v[64:67]
    ds_read_b64_tr_b16 v[32:33], v12 offset:24576
    v_mfma_f32_16x16x32_bf16 v[68:71], v[40:43], v[212:215], v[68:71]
    ds_read_b64_tr_b16 v[34:35], v12 offset:25600
    v_mfma_f32_16x16x32_bf16 v[56:59], v[28:31], v[40:43], v[56:59]
    s_waitcnt lgkmcnt(6)
    v_mfma_f32_16x16x32_bf16 v[72:75], v[44:47], v[208:211], v[72:75]
    ds_read_b64_tr_b16 v[36:37], v13 offset:24576
    v_mfma_f32_16x16x32_bf16 v[76:79], v[44:47], v[212:215], v[76:79]
    ds_read_b64_tr_b16 v[38:39], v13 offset:25600
    v_mfma_f32_16x16x32_bf16 v[60:63], v[28:31], v[44:47], v[60:63]
    s_waitcnt lgkmcnt(6)
    v_mfma_f32_16x16x32_bf16 v[80:83], v[48:51], v[208:211], v[80:83]
    ds_read_b64_tr_b16 v[40:41], v14 offset:24576
    v_mfma_f32_16x16x32_bf16 v[84:87], v[48:51], v[212:215], v[84:87]
    ds_read_b64_tr_b16 v[42:43], v14 offset:25600
    s_waitcnt lgkmcnt(6)
    v_mfma_f32_16x16x32_bf16 v[88:91], v[52:55], v[208:211], v[88:91]
    ds_read_b64_tr_b16 v[44:45], v15 offset:24576
    v_mfma_f32_16x16x32_bf16 v[92:95], v[52:55], v[212:215], v[92:95]
    ds_read_b64_tr_b16 v[46:47], v15 offset:25600
    s_waitcnt lgkmcnt(6)
    v_mfma_f32_16x16x32_bf16 v[96:99], v[32:35], v[208:211], v[96:99]
    ds_read_b64_tr_b16 v[48:49], v8 offset:32768
    v_mfma_f32_16x16x32_bf16 v[100:103], v[32:35], v[212:215], v[100:103]
    ds_read_b64_tr_b16 v[50:51], v8 offset:33792
    s_waitcnt lgkmcnt(6)
    v_mfma_f32_16x16x32_bf16 v[104:107], v[36:39], v[208:211], v[104:107]
    ds_read_b64_tr_b16 v[52:53], v9 offset:32768
    v_mfma_f32_16x16x32_bf16 v[108:111], v[36:39], v[212:215], v[108:111]
    ds_read_b64_tr_b16 v[54:55], v9 offset:33792
    s_waitcnt lgkmcnt(6)
    v_mfma_f32_16x16x32_bf16 v[112:115], v[40:43], v[208:211], v[112:115]
    ds_read_b64_tr_b16 v[32:33], v10 offset:32768
    v_mfma_f32_16x16x32_bf16 v[116:119], v[40:43], v[212:215], v[116:119]
    ds_read_b64_tr_b16 v[34:35], v10 offset:33792
    s_waitcnt lgkmcnt(6)
    v_mfma_f32_16x16x32_bf16 v[120:123], v[44:47], v[208:211], v[120:123]
    ds_read_b64_tr_b16 v[36:37], v11 offset:32768
    v_mfma_f32_16x16x32_bf16 v[124:127], v[44:47], v[212:215], v[124:127]
    ds_read_b64_tr_b16 v[38:39], v11 offset:33792
    s_waitcnt lgkmcnt(6)
    v_mfma_f32_16x16x32_bf16 v[64:67], v[48:51], v[216:219], v[64:67]
    ds_read_b64_tr_b16 v[40:41], v12 offset:32768
    v_mfma_f32_16x16x32_bf16 v[68:71], v[48:51], v[220:223], v[68:71]
    ds_read_b64_tr_b16 v[42:43], v12 offset:33792
    v_mfma_f32_16x16x32_bf16 v[56:59], v[28:31], v[48:51], v[56:59]
    s_waitcnt lgkmcnt(6)
    v_mfma_f32_16x16x32_bf16 v[72:75], v[52:55], v[216:219], v[72:75]
    ds_read_b64_tr_b16 v[44:45], v13 offset:32768
    v_mfma_f32_16x16x32_bf16 v[76:79], v[52:55], v[220:223], v[76:79]
    ds_read_b64_tr_b16 v[46:47], v13 offset:33792
    v_mfma_f32_16x16x32_bf16 v[60:63], v[28:31], v[52:55], v[60:63]
    s_waitcnt lgkmcnt(6)
    v_mfma_f32_16x16x32_bf16 v[80:83], v[32:35], v[216:219], v[80:83]
    ds_read_b64_tr_b16 v[48:49], v14 offset:32768
    v_mfma_f32_16x16x32_bf16 v[84:87], v[32:35], v[220:223], v[84:87]
    ds_read_b64_tr_b16 v[50:51], v14 offset:33792
    s_waitcnt lgkmcnt(6)
    v_mfma_f32_16x16x32_bf16 v[88:91], v[36:39], v[216:219], v[88:91]
    ds_read_b64_tr_b16 v[52:53], v15 offset:32768
    v_mfma_f32_16x16x32_bf16 v[92:95], v[36:39], v[220:223], v[92:95]
    ds_read_b64_tr_b16 v[54:55], v15 offset:33792
    s_waitcnt lgkmcnt(6)
    v_mfma_f32_16x16x32_bf16 v[96:99], v[40:43], v[216:219], v[96:99]
    s_barrier
    ds_read_b64_tr_b16 v[32:33], v8 offset:40960
    v_mfma_f32_16x16x32_bf16 v[100:103], v[40:43], v[220:223], v[100:103]
    ds_read_b64_tr_b16 v[34:35], v8 offset:41984
    s_waitcnt lgkmcnt(6)
    v_mfma_f32_16x16x32_bf16 v[104:107], v[44:47], v[216:219], v[104:107]
    ds_read_b64_tr_b16 v[36:37], v9 offset:40960
    v_mfma_f32_16x16x32_bf16 v[108:111], v[44:47], v[220:223], v[108:111]
    ds_read_b64_tr_b16 v[38:39], v9 offset:41984
    s_waitcnt lgkmcnt(6)
    v_mfma_f32_16x16x32_bf16 v[112:115], v[48:51], v[216:219], v[112:115]
    ds_read_b64_tr_b16 v[40:41], v10 offset:40960
    v_mfma_f32_16x16x32_bf16 v[116:119], v[48:51], v[220:223], v[116:119]
    ds_read_b64_tr_b16 v[42:43], v10 offset:41984
    s_waitcnt lgkmcnt(6)
    v_mfma_f32_16x16x32_bf16 v[120:123], v[52:55], v[216:219], v[120:123]
    ds_read_b64_tr_b16 v[44:45], v11 offset:40960
    v_mfma_f32_16x16x32_bf16 v[124:127], v[52:55], v[220:223], v[124:127]
    ds_read_b64_tr_b16 v[46:47], v11 offset:41984
    s_waitcnt lgkmcnt(6)
    v_mfma_f32_16x16x32_bf16 v[64:67], v[32:35], v[224:227], v[64:67]
    ds_read_b64_tr_b16 v[48:49], v12 offset:40960
    v_mfma_f32_16x16x32_bf16 v[68:71], v[32:35], v[228:231], v[68:71]
    ds_read_b64_tr_b16 v[50:51], v12 offset:41984
    v_mfma_f32_16x16x32_bf16 v[56:59], v[28:31], v[32:35], v[56:59]
    s_waitcnt lgkmcnt(6)
    v_mfma_f32_16x16x32_bf16 v[72:75], v[36:39], v[224:227], v[72:75]
    ds_read_b64_tr_b16 v[52:53], v13 offset:40960
    v_mfma_f32_16x16x32_bf16 v[76:79], v[36:39], v[228:231], v[76:79]
    ds_read_b64_tr_b16 v[54:55], v13 offset:41984
    v_mfma_f32_16x16x32_bf16 v[60:63], v[28:31], v[36:39], v[60:63]
    s_waitcnt lgkmcnt(6)
    v_mfma_f32_16x16x32_bf16 v[80:83], v[40:43], v[224:227], v[80:83]
    ds_read_b64_tr_b16 v[32:33], v14 offset:40960
    v_mfma_f32_16x16x32_bf16 v[84:87], v[40:43], v[228:231], v[84:87]
    ds_read_b64_tr_b16 v[34:35], v14 offset:41984
    s_waitcnt lgkmcnt(6)
    v_mfma_f32_16x16x32_bf16 v[88:91], v[44:47], v[224:227], v[88:91]
    ds_read_b64_tr_b16 v[36:37], v15 offset:40960
    v_mfma_f32_16x16x32_bf16 v[92:95], v[44:47], v[228:231], v[92:95]
    ds_read_b64_tr_b16 v[38:39], v15 offset:41984
    s_waitcnt lgkmcnt(6)
    v_mfma_f32_16x16x32_bf16 v[96:99], v[48:51], v[224:227], v[96:99]
    ds_read_b64_tr_b16 v[40:41], v8 offset:49152
    v_mfma_f32_16x16x32_bf16 v[100:103], v[48:51], v[228:231], v[100:103]
    ds_read_b64_tr_b16 v[42:43], v8 offset:50176
    s_waitcnt lgkmcnt(6)
    v_mfma_f32_16x16x32_bf16 v[104:107], v[52:55], v[224:227], v[104:107]
    ds_read_b64_tr_b16 v[44:45], v9 offset:49152
    v_mfma_f32_16x16x32_bf16 v[108:111], v[52:55], v[228:231], v[108:111]
    ds_read_b64_tr_b16 v[46:47], v9 offset:50176
    s_waitcnt lgkmcnt(6)
    v_mfma_f32_16x16x32_bf16 v[112:115], v[32:35], v[224:227], v[112:115]
    ds_read_b64_tr_b16 v[48:49], v10 offset:49152
    v_mfma_f32_16x16x32_bf16 v[116:119], v[32:35], v[228:231], v[116:119]
    ds_read_b64_tr_b16 v[50:51], v10 offset:50176
    s_waitcnt lgkmcnt(6)
    v_mfma_f32_16x16x32_bf16 v[120:123], v[36:39], v[224:227], v[120:123]
    ds_read_b64_tr_b16 v[52:53], v11 offset:49152
    v_mfma_f32_16x16x32_bf16 v[124:127], v[36:39], v[228:231], v[124:127]
    ds_read_b64_tr_b16 v[54:55], v11 offset:50176
    s_waitcnt lgkmcnt(6)
    v_mfma_f32_16x16x32_bf16 v[64:67], v[40:43], v[232:235], v[64:67]
    ds_read_b64_tr_b16 v[32:33], v12 offset:49152
    v_mfma_f32_16x16x32_bf16 v[68:71], v[40:43], v[236:239], v[68:71]
    ds_read_b64_tr_b16 v[34:35], v12 offset:50176
    v_mfma_f32_16x16x32_bf16 v[56:59], v[28:31], v[40:43], v[56:59]
    s_waitcnt lgkmcnt(6)
    v_mfma_f32_16x16x32_bf16 v[72:75], v[44:47], v[232:235], v[72:75]
    ds_read_b64_tr_b16 v[36:37], v13 offset:49152
    v_mfma_f32_16x16x32_bf16 v[76:79], v[44:47], v[236:239], v[76:79]
    ds_read_b64_tr_b16 v[38:39], v13 offset:50176
    v_mfma_f32_16x16x32_bf16 v[60:63], v[28:31], v[44:47], v[60:63]
    s_waitcnt lgkmcnt(6)
    v_mfma_f32_16x16x32_bf16 v[80:83], v[48:51], v[232:235], v[80:83]
    ds_read_b64_tr_b16 v[40:41], v14 offset:49152
    v_mfma_f32_16x16x32_bf16 v[84:87], v[48:51], v[236:239], v[84:87]
    ds_read_b64_tr_b16 v[42:43], v14 offset:50176
    s_waitcnt lgkmcnt(6)
    v_mfma_f32_16x16x32_bf16 v[88:91], v[52:55], v[232:235], v[88:91]
    ds_read_b64_tr_b16 v[44:45], v15 offset:49152
    v_mfma_f32_16x16x32_bf16 v[92:95], v[52:55], v[236:239], v[92:95]
    ds_read_b64_tr_b16 v[46:47], v15 offset:50176
    s_waitcnt lgkmcnt(6)
    v_mfma_f32_16x16x32_bf16 v[96:99], v[32:35], v[232:235], v[96:99]
    s_barrier
    ds_read_b64_tr_b16 v[48:49], v8 offset:0
    v_mfma_f32_16x16x32_bf16 v[100:103], v[32:35], v[236:239], v[100:103]
    ds_read_b64_tr_b16 v[50:51], v8 offset:1024
    s_waitcnt lgkmcnt(6)
    v_mfma_f32_16x16x32_bf16 v[104:107], v[36:39], v[232:235], v[104:107]
    ds_read_b64_tr_b16 v[52:53], v9 offset:0
    v_mfma_f32_16x16x32_bf16 v[108:111], v[36:39], v[236:239], v[108:111]
    ds_read_b64_tr_b16 v[54:55], v9 offset:1024
    s_waitcnt lgkmcnt(6)
    v_mfma_f32_16x16x32_bf16 v[112:115], v[40:43], v[232:235], v[112:115]
    ds_read_b64_tr_b16 v[32:33], v10 offset:0
    v_mfma_f32_16x16x32_bf16 v[116:119], v[40:43], v[236:239], v[116:119]
    ds_read_b64_tr_b16 v[34:35], v10 offset:1024
    s_waitcnt lgkmcnt(6)
    v_mfma_f32_16x16x32_bf16 v[120:123], v[44:47], v[232:235], v[120:123]
    ds_read_b64_tr_b16 v[36:37], v11 offset:0
    v_mfma_f32_16x16x32_bf16 v[124:127], v[44:47], v[236:239], v[124:127]
    ds_read_b64_tr_b16 v[38:39], v11 offset:1024
    s_waitcnt lgkmcnt(6)
    v_mfma_f32_16x16x32_bf16 v[64:67], v[48:51], v[240:243], v[64:67]
    ds_read_b64_tr_b16 v[40:41], v12 offset:0
    v_mfma_f32_16x16x32_bf16 v[68:71], v[48:51], v[244:247], v[68:71]
    ds_read_b64_tr_b16 v[42:43], v12 offset:1024
    v_mfma_f32_16x16x32_bf16 v[56:59], v[28:31], v[48:51], v[56:59]
    s_waitcnt lgkmcnt(6)
    v_mfma_f32_16x16x32_bf16 v[72:75], v[52:55], v[240:243], v[72:75]
    ds_read_b64_tr_b16 v[44:45], v13 offset:0
    v_mfma_f32_16x16x32_bf16 v[76:79], v[52:55], v[244:247], v[76:79]
    ds_read_b64_tr_b16 v[46:47], v13 offset:1024
    v_mfma_f32_16x16x32_bf16 v[60:63], v[28:31], v[52:55], v[60:63]
    s_waitcnt lgkmcnt(6)
    v_mfma_f32_16x16x32_bf16 v[80:83], v[32:35], v[240:243], v[80:83]
    ds_read_b64_tr_b16 v[48:49], v14 offset:0
    v_mfma_f32_16x16x32_bf16 v[84:87], v[32:35], v[244:247], v[84:87]
    ds_read_b64_tr_b16 v[50:51], v14 offset:1024
    s_waitcnt lgkmcnt(6)
    v_mfma_f32_16x16x32_bf16 v[88:91], v[36:39], v[240:243], v[88:91]
    ds_read_b64_tr_b16 v[52:53], v15 offset:0
    v_mfma_f32_16x16x32_bf16 v[92:95], v[36:39], v[244:247], v[92:95]
    ds_read_b64_tr_b16 v[54:55], v15 offset:1024
    s_waitcnt lgkmcnt(6)
    v_mfma_f32_16x16x32_bf16 v[96:99], v[40:43], v[240:243], v[96:99]
    ds_read_b64_tr_b16 v[32:33], v8 offset:8192
    v_mfma_f32_16x16x32_bf16 v[100:103], v[40:43], v[244:247], v[100:103]
    ds_read_b64_tr_b16 v[34:35], v8 offset:9216
    s_waitcnt lgkmcnt(6)
    v_mfma_f32_16x16x32_bf16 v[104:107], v[44:47], v[240:243], v[104:107]
    ds_read_b64_tr_b16 v[36:37], v9 offset:8192
    v_mfma_f32_16x16x32_bf16 v[108:111], v[44:47], v[244:247], v[108:111]
    ds_read_b64_tr_b16 v[38:39], v9 offset:9216
    s_waitcnt lgkmcnt(6)
    v_mfma_f32_16x16x32_bf16 v[112:115], v[48:51], v[240:243], v[112:115]
    ds_read_b64_tr_b16 v[40:41], v10 offset:8192
    v_mfma_f32_16x16x32_bf16 v[116:119], v[48:51], v[244:247], v[116:119]
    ds_read_b64_tr_b16 v[42:43], v10 offset:9216
    s_waitcnt lgkmcnt(6)
    v_mfma_f32_16x16x32_bf16 v[120:123], v[52:55], v[240:243], v[120:123]
    ds_read_b64_tr_b16 v[44:45], v11 offset:8192
    v_mfma_f32_16x16x32_bf16 v[124:127], v[52:55], v[244:247], v[124:127]
    ds_read_b64_tr_b16 v[46:47], v11 offset:9216
    s_waitcnt lgkmcnt(6)
    v_mfma_f32_16x16x32_bf16 v[64:67], v[32:35], v[248:251], v[64:67]
    ds_read_b64_tr_b16 v[48:49], v12 offset:8192
    v_mfma_f32_16x16x32_bf16 v[68:71], v[32:35], v[252:255], v[68:71]
    ds_read_b64_tr_b16 v[50:51], v12 offset:9216
    v_mfma_f32_16x16x32_bf16 v[56:59], v[28:31], v[32:35], v[56:59]
    s_waitcnt lgkmcnt(6)
    v_mfma_f32_16x16x32_bf16 v[72:75], v[36:39], v[248:251], v[72:75]
    ds_read_b64_tr_b16 v[52:53], v13 offset:8192
    v_mfma_f32_16x16x32_bf16 v[76:79], v[36:39], v[252:255], v[76:79]
    ds_read_b64_tr_b16 v[54:55], v13 offset:9216
    v_mfma_f32_16x16x32_bf16 v[60:63], v[28:31], v[36:39], v[60:63]
    s_waitcnt lgkmcnt(6)
    v_mfma_f32_16x16x32_bf16 v[80:83], v[40:43], v[248:251], v[80:83]
    ds_read_b64_tr_b16 v[32:33], v14 offset:8192
    v_mfma_f32_16x16x32_bf16 v[84:87], v[40:43], v[252:255], v[84:87]
    ds_read_b64_tr_b16 v[34:35], v14 offset:9216
    s_waitcnt lgkmcnt(6)
    v_mfma_f32_16x16x32_bf16 v[88:91], v[44:47], v[248:251], v[88:91]
    ds_read_b64_tr_b16 v[36:37], v15 offset:8192
    v_mfma_f32_16x16x32_bf16 v[92:95], v[44:47], v[252:255], v[92:95]
    ds_read_b64_tr_b16 v[38:39], v15 offset:9216
    v_and_b32 v57, s76, v56
    v_sub_f32 v56, v56, v57
    v_cvt_pk_bf16_f32 v56, v57, v56
    v_mov_b32 v57, v26
    ds_write_b64 v18, v[56:57] offset:0
    s_waitcnt lgkmcnt(7)
    v_mfma_f32_16x16x32_bf16 v[96:99], v[48:51], v[248:251], v[96:99]
    v_mfma_f32_16x16x32_bf16 v[100:103], v[48:51], v[252:255], v[100:103]
    v_and_b32 v61, s76, v60
    v_sub_f32 v60, v60, v61
    v_cvt_pk_bf16_f32 v60, v61, v60
    v_mov_b32 v61, v27
    ds_write_b64 v18, v[60:61] offset:128
    s_waitcnt lgkmcnt(6)
    v_mfma_f32_16x16x32_bf16 v[104:107], v[52:55], v[248:251], v[104:107]
    v_mfma_f32_16x16x32_bf16 v[108:111], v[52:55], v[252:255], v[108:111]
    v_mov_b32 v8, v18
    v_xor_b32 v9, 256, v18
    v_xor_b32 v10, 512, v18
    v_xor_b32 v11, 768, v18
    s_waitcnt lgkmcnt(0)
    v_mfma_f32_16x16x32_bf16 v[112:115], v[32:35], v[248:251], v[112:115]
    s_barrier
    ds_read_b64 v[128:129], v8 offset:0
    ds_read_b64 v[130:131], v8 offset:128
    v_mfma_f32_16x16x32_bf16 v[116:119], v[32:35], v[252:255], v[116:119]
    ds_read_b64 v[132:133], v9 offset:0
    ds_read_b64 v[134:135], v9 offset:128
    v_mfma_f32_16x16x32_bf16 v[120:123], v[36:39], v[248:251], v[120:123]
    ds_read_b64 v[136:137], v10 offset:0
    ds_read_b64 v[138:139], v10 offset:128
    v_mfma_f32_16x16x32_bf16 v[124:127], v[36:39], v[252:255], v[124:127]
    ds_read_b64 v[140:141], v11 offset:0
    ds_read_b64 v[142:143], v11 offset:128
    s_waitcnt lgkmcnt(0)
    s_barrier
    v_mfma_f32_16x16x16_bf16 v[64:67], v[128:129], v[22:23], v[64:67]
    v_mfma_f32_16x16x16_bf16 v[68:71], v[128:129], v[24:25], v[68:71]
    v_mfma_f32_16x16x16_bf16 v[72:75], v[130:131], v[22:23], v[72:75]
    v_mfma_f32_16x16x16_bf16 v[76:79], v[130:131], v[24:25], v[76:79]
    v_mfma_f32_16x16x16_bf16 v[80:83], v[132:133], v[22:23], v[80:83]
    v_mfma_f32_16x16x16_bf16 v[84:87], v[132:133], v[24:25], v[84:87]
    v_mfma_f32_16x16x16_bf16 v[88:91], v[134:135], v[22:23], v[88:91]
    v_mfma_f32_16x16x16_bf16 v[92:95], v[134:135], v[24:25], v[92:95]
    v_mfma_f32_16x16x16_bf16 v[96:99], v[136:137], v[22:23], v[96:99]
    v_mfma_f32_16x16x16_bf16 v[100:103], v[136:137], v[24:25], v[100:103]
    v_mfma_f32_16x16x16_bf16 v[104:107], v[138:139], v[22:23], v[104:107]
    v_mfma_f32_16x16x16_bf16 v[108:111], v[138:139], v[24:25], v[108:111]
    v_mfma_f32_16x16x16_bf16 v[112:115], v[140:141], v[22:23], v[112:115]
    v_mfma_f32_16x16x16_bf16 v[116:119], v[140:141], v[24:25], v[116:119]
    v_mfma_f32_16x16x16_bf16 v[120:123], v[142:143], v[22:23], v[120:123]
    v_mfma_f32_16x16x16_bf16 v[124:127], v[142:143], v[24:25], v[124:127]
    s_mul_i32 s20, s88, 44
    s_add_u32 s20, s20, s29
    s_add_u32 s20, s20, s89
    s_add_u32 s20, s20, 16
    s_and_b32 s21, s33, 1
    s_lshl2_add_u32 s71, s20, s21
    s_lshl_b32 s71, s71, 11
    s_add_u32 s71, s71, 2097152
    s_mul_i32 s22, s21, 5120
    v_add_u32 v224, s22, v6
    v_xor_b32 v225, 1024, v224
    v_xor_b32 v226, 5120, v224
    v_xor_b32 v227, 4096, v224
    s_mul_i32 s22, s88, 6
    s_lshr_b32 s23, s28, 2
    s_add_u32 s22, s22, s23
    s_add_u32 s22, s22, 2
    s_lshl_b32 s22, s22, 8
    s_and_b32 s23, s28, 3
    s_lshl1_add_u32 s70, s23, s89
    s_lshl1_add_u32 s23, s23, s21
    s_lshl2_add_u32 s75, s23, s22
    s_setprio 2
    s_lshl_b32 s20, s89, 14
    s_add_u32 s74, s71, 8192
    s_sub_u32 s74, s74, s20
    .p2align 3
    s_cmp_eq_u32 s70, 7
    s_cbranch_scc1 L_join_10
    v_pk_mul_f32 v[64:65], v[64:65], v[20:21] op_sel_hi:[1,0]
    v_pk_mul_f32 v[66:67], v[66:67], v[20:21] op_sel_hi:[1,0]
    v_exp_f32 v228, v64
    v_exp_f32 v229, v65
    v_exp_f32 v230, v66
    v_exp_f32 v231, v67
    v_pk_fma_f32 v[232:233], v[228:229], 0.5, 1.0 op_sel_hi:[1,0,0]
    v_pk_fma_f32 v[234:235], v[230:231], 0.5, 1.0 op_sel_hi:[1,0,0]
    v_pk_fma_f32 v[232:233], v[228:229], v[232:233], 1.0 op_sel_hi:[1,1,0]
    v_pk_fma_f32 v[234:235], v[230:231], v[234:235], 1.0 op_sel_hi:[1,1,0]
    v_rcp_f32 v232, v232
    v_rcp_f32 v233, v233
    v_rcp_f32 v234, v234
    v_rcp_f32 v235, v235
    v_pk_fma_f32 v[64:65], v[64:65], v[232:233], v[64:65] neg_lo:[1,0,0] neg_hi:[1,0,0]
    v_pk_fma_f32 v[66:67], v[66:67], v[234:235], v[66:67] neg_lo:[1,0,0] neg_hi:[1,0,0]
    v_cvt_pk_bf16_f32 v192, v64, v65
    v_cvt_pk_bf16_f32 v193, v66, v67
    v_pk_mul_f32 v[72:73], v[72:73], v[20:21] op_sel_hi:[1,0]
    v_pk_mul_f32 v[74:75], v[74:75], v[20:21] op_sel_hi:[1,0]
    v_exp_f32 v228, v72
    v_exp_f32 v229, v73
    v_exp_f32 v230, v74
    v_exp_f32 v231, v75
    v_pk_fma_f32 v[232:233], v[228:229], 0.5, 1.0 op_sel_hi:[1,0,0]
    v_pk_fma_f32 v[234:235], v[230:231], 0.5, 1.0 op_sel_hi:[1,0,0]
    v_pk_fma_f32 v[232:233], v[228:229], v[232:233], 1.0 op_sel_hi:[1,1,0]
    v_pk_fma_f32 v[234:235], v[230:231], v[234:235], 1.0 op_sel_hi:[1,1,0]
    v_rcp_f32 v232, v232
    v_rcp_f32 v233, v233
    v_rcp_f32 v234, v234
    v_rcp_f32 v235, v235
    v_pk_fma_f32 v[72:73], v[72:73], v[232:233], v[72:73] neg_lo:[1,0,0] neg_hi:[1,0,0]
    v_pk_fma_f32 v[74:75], v[74:75], v[234:235], v[74:75] neg_lo:[1,0,0] neg_hi:[1,0,0]
    v_cvt_pk_bf16_f32 v194, v72, v73
    v_cvt_pk_bf16_f32 v195, v74, v75
    buffer_store_dwordx4 v[192:195], v224, s[16:19], s71 offen sc1
    v_pk_mul_f32 v[68:69], v[68:69], v[20:21] op_sel:[0,1] op_sel_hi:[1,1]
    v_pk_mul_f32 v[70:71], v[70:71], v[20:21] op_sel:[0,1] op_sel_hi:[1,1]
    v_exp_f32 v228, v68
    v_exp_f32 v229, v69
    v_exp_f32 v230, v70
    v_exp_f32 v231, v71
    v_pk_fma_f32 v[232:233], v[228:229], 0.5, 1.0 op_sel_hi:[1,0,0]
    v_pk_fma_f32 v[234:235], v[230:231], 0.5, 1.0 op_sel_hi:[1,0,0]
    v_pk_fma_f32 v[232:233], v[228:229], v[232:233], 1.0 op_sel_hi:[1,1,0]
    v_pk_fma_f32 v[234:235], v[230:231], v[234:235], 1.0 op_sel_hi:[1,1,0]
    v_rcp_f32 v232, v232
    v_rcp_f32 v233, v233
    v_rcp_f32 v234, v234
    v_rcp_f32 v235, v235
    v_pk_fma_f32 v[68:69], v[68:69], v[232:233], v[68:69] neg_lo:[1,0,0] neg_hi:[1,0,0]
    v_pk_fma_f32 v[70:71], v[70:71], v[234:235], v[70:71] neg_lo:[1,0,0] neg_hi:[1,0,0]
    v_cvt_pk_bf16_f32 v196, v68, v69
    v_cvt_pk_bf16_f32 v197, v70, v71
    v_pk_mul_f32 v[76:77], v[76:77], v[20:21] op_sel:[0,1] op_sel_hi:[1,1]
    v_pk_mul_f32 v[78:79], v[78:79], v[20:21] op_sel:[0,1] op_sel_hi:[1,1]
    v_exp_f32 v228, v76
    v_exp_f32 v229, v77
    v_exp_f32 v230, v78
    v_exp_f32 v231, v79
    v_pk_fma_f32 v[232:233], v[228:229], 0.5, 1.0 op_sel_hi:[1,0,0]
    v_pk_fma_f32 v[234:235], v[230:231], 0.5, 1.0 op_sel_hi:[1,0,0]
    v_pk_fma_f32 v[232:233], v[228:229], v[232:233], 1.0 op_sel_hi:[1,1,0]
    v_pk_fma_f32 v[234:235], v[230:231], v[234:235], 1.0 op_sel_hi:[1,1,0]
    v_rcp_f32 v232, v232
    v_rcp_f32 v233, v233
    v_rcp_f32 v234, v234
    v_rcp_f32 v235, v235
    v_pk_fma_f32 v[76:77], v[76:77], v[232:233], v[76:77] neg_lo:[1,0,0] neg_hi:[1,0,0]
    v_pk_fma_f32 v[78:79], v[78:79], v[234:235], v[78:79] neg_lo:[1,0,0] neg_hi:[1,0,0]
    v_cvt_pk_bf16_f32 v198, v76, v77
    v_cvt_pk_bf16_f32 v199, v78, v79
    buffer_store_dwordx4 v[196:199], v225, s[16:19], s71 offen sc1
    v_pk_mul_f32 v[80:81], v[80:81], v[20:21] op_sel_hi:[1,0]
    v_pk_mul_f32 v[82:83], v[82:83], v[20:21] op_sel_hi:[1,0]
    v_exp_f32 v228, v80
    v_exp_f32 v229, v81
    v_exp_f32 v230, v82
    v_exp_f32 v231, v83
    v_pk_fma_f32 v[232:233], v[228:229], 0.5, 1.0 op_sel_hi:[1,0,0]
    v_pk_fma_f32 v[234:235], v[230:231], 0.5, 1.0 op_sel_hi:[1,0,0]
    v_pk_fma_f32 v[232:233], v[228:229], v[232:233], 1.0 op_sel_hi:[1,1,0]
    v_pk_fma_f32 v[234:235], v[230:231], v[234:235], 1.0 op_sel_hi:[1,1,0]
    v_rcp_f32 v232, v232
    v_rcp_f32 v233, v233
    v_rcp_f32 v234, v234
    v_rcp_f32 v235, v235
    v_pk_fma_f32 v[80:81], v[80:81], v[232:233], v[80:81] neg_lo:[1,0,0] neg_hi:[1,0,0]
    v_pk_fma_f32 v[82:83], v[82:83], v[234:235], v[82:83] neg_lo:[1,0,0] neg_hi:[1,0,0]
    v_cvt_pk_bf16_f32 v200, v80, v81
    v_cvt_pk_bf16_f32 v201, v82, v83
    v_pk_mul_f32 v[88:89], v[88:89], v[20:21] op_sel_hi:[1,0]
    v_pk_mul_f32 v[90:91], v[90:91], v[20:21] op_sel_hi:[1,0]
    v_exp_f32 v228, v88
    v_exp_f32 v229, v89
    v_exp_f32 v230, v90
    v_exp_f32 v231, v91
    v_pk_fma_f32 v[232:233], v[228:229], 0.5, 1.0 op_sel_hi:[1,0,0]
    v_pk_fma_f32 v[234:235], v[230:231], 0.5, 1.0 op_sel_hi:[1,0,0]
    v_pk_fma_f32 v[232:233], v[228:229], v[232:233], 1.0 op_sel_hi:[1,1,0]
    v_pk_fma_f32 v[234:235], v[230:231], v[234:235], 1.0 op_sel_hi:[1,1,0]
    v_rcp_f32 v232, v232
    v_rcp_f32 v233, v233
    v_rcp_f32 v234, v234
    v_rcp_f32 v235, v235
    v_pk_fma_f32 v[88:89], v[88:89], v[232:233], v[88:89] neg_lo:[1,0,0] neg_hi:[1,0,0]
    v_pk_fma_f32 v[90:91], v[90:91], v[234:235], v[90:91] neg_lo:[1,0,0] neg_hi:[1,0,0]
    v_cvt_pk_bf16_f32 v202, v88, v89
    v_cvt_pk_bf16_f32 v203, v90, v91
    buffer_store_dwordx4 v[200:203], v226, s[16:19], s71 offen sc1
    v_pk_mul_f32 v[84:85], v[84:85], v[20:21] op_sel:[0,1] op_sel_hi:[1,1]
    v_pk_mul_f32 v[86:87], v[86:87], v[20:21] op_sel:[0,1] op_sel_hi:[1,1]
    v_exp_f32 v228, v84
    v_exp_f32 v229, v85
    v_exp_f32 v230, v86
    v_exp_f32 v231, v87
    v_pk_fma_f32 v[232:233], v[228:229], 0.5, 1.0 op_sel_hi:[1,0,0]
    v_pk_fma_f32 v[234:235], v[230:231], 0.5, 1.0 op_sel_hi:[1,0,0]
    v_pk_fma_f32 v[232:233], v[228:229], v[232:233], 1.0 op_sel_hi:[1,1,0]
    v_pk_fma_f32 v[234:235], v[230:231], v[234:235], 1.0 op_sel_hi:[1,1,0]
    v_rcp_f32 v232, v232
    v_rcp_f32 v233, v233
    v_rcp_f32 v234, v234
    v_rcp_f32 v235, v235
    v_pk_fma_f32 v[84:85], v[84:85], v[232:233], v[84:85] neg_lo:[1,0,0] neg_hi:[1,0,0]
    v_pk_fma_f32 v[86:87], v[86:87], v[234:235], v[86:87] neg_lo:[1,0,0] neg_hi:[1,0,0]
    v_cvt_pk_bf16_f32 v204, v84, v85
    v_cvt_pk_bf16_f32 v205, v86, v87
    v_pk_mul_f32 v[92:93], v[92:93], v[20:21] op_sel:[0,1] op_sel_hi:[1,1]
    v_pk_mul_f32 v[94:95], v[94:95], v[20:21] op_sel:[0,1] op_sel_hi:[1,1]
    v_exp_f32 v228, v92
    v_exp_f32 v229, v93
    v_exp_f32 v230, v94
    v_exp_f32 v231, v95
    v_pk_fma_f32 v[232:233], v[228:229], 0.5, 1.0 op_sel_hi:[1,0,0]
    v_pk_fma_f32 v[234:235], v[230:231], 0.5, 1.0 op_sel_hi:[1,0,0]
    v_pk_fma_f32 v[232:233], v[228:229], v[232:233], 1.0 op_sel_hi:[1,1,0]
    v_pk_fma_f32 v[234:235], v[230:231], v[234:235], 1.0 op_sel_hi:[1,1,0]
    v_rcp_f32 v232, v232
    v_rcp_f32 v233, v233
    v_rcp_f32 v234, v234
    v_rcp_f32 v235, v235
    v_pk_fma_f32 v[92:93], v[92:93], v[232:233], v[92:93] neg_lo:[1,0,0] neg_hi:[1,0,0]
    v_pk_fma_f32 v[94:95], v[94:95], v[234:235], v[94:95] neg_lo:[1,0,0] neg_hi:[1,0,0]
    v_cvt_pk_bf16_f32 v206, v92, v93
    v_cvt_pk_bf16_f32 v207, v94, v95
    buffer_store_dwordx4 v[204:207], v227, s[16:19], s71 offen sc1
L_join_10:
    .p2align 3
    s_cmp_eq_u32 s70, 6
    s_cbranch_scc1 L_join_11
    v_pk_mul_f32 v[96:97], v[96:97], v[20:21] op_sel_hi:[1,0]
    v_pk_mul_f32 v[98:99], v[98:99], v[20:21] op_sel_hi:[1,0]
    v_exp_f32 v228, v96
    v_exp_f32 v229, v97
    v_exp_f32 v230, v98
    v_exp_f32 v231, v99
    v_pk_fma_f32 v[232:233], v[228:229], 0.5, 1.0 op_sel_hi:[1,0,0]
    v_pk_fma_f32 v[234:235], v[230:231], 0.5, 1.0 op_sel_hi:[1,0,0]
    v_pk_fma_f32 v[232:233], v[228:229], v[232:233], 1.0 op_sel_hi:[1,1,0]
    v_pk_fma_f32 v[234:235], v[230:231], v[234:235], 1.0 op_sel_hi:[1,1,0]
    v_rcp_f32 v232, v232
    v_rcp_f32 v233, v233
    v_rcp_f32 v234, v234
    v_rcp_f32 v235, v235
    v_pk_fma_f32 v[96:97], v[96:97], v[232:233], v[96:97] neg_lo:[1,0,0] neg_hi:[1,0,0]
    v_pk_fma_f32 v[98:99], v[98:99], v[234:235], v[98:99] neg_lo:[1,0,0] neg_hi:[1,0,0]
    v_cvt_pk_bf16_f32 v208, v96, v97
    v_cvt_pk_bf16_f32 v209, v98, v99
    v_pk_mul_f32 v[104:105], v[104:105], v[20:21] op_sel_hi:[1,0]
    v_pk_mul_f32 v[106:107], v[106:107], v[20:21] op_sel_hi:[1,0]
    v_exp_f32 v228, v104
    v_exp_f32 v229, v105
    v_exp_f32 v230, v106
    v_exp_f32 v231, v107
    v_pk_fma_f32 v[232:233], v[228:229], 0.5, 1.0 op_sel_hi:[1,0,0]
    v_pk_fma_f32 v[234:235], v[230:231], 0.5, 1.0 op_sel_hi:[1,0,0]
    v_pk_fma_f32 v[232:233], v[228:229], v[232:233], 1.0 op_sel_hi:[1,1,0]
    v_pk_fma_f32 v[234:235], v[230:231], v[234:235], 1.0 op_sel_hi:[1,1,0]
    v_rcp_f32 v232, v232
    v_rcp_f32 v233, v233
    v_rcp_f32 v234, v234
    v_rcp_f32 v235, v235
    v_pk_fma_f32 v[104:105], v[104:105], v[232:233], v[104:105] neg_lo:[1,0,0] neg_hi:[1,0,0]
    v_pk_fma_f32 v[106:107], v[106:107], v[234:235], v[106:107] neg_lo:[1,0,0] neg_hi:[1,0,0]
    v_cvt_pk_bf16_f32 v210, v104, v105
    v_cvt_pk_bf16_f32 v211, v106, v107
    buffer_store_dwordx4 v[208:211], v224, s[16:19], s74 offen sc1
    v_pk_mul_f32 v[100:101], v[100:101], v[20:21] op_sel:[0,1] op_sel_hi:[1,1]
    v_pk_mul_f32 v[102:103], v[102:103], v[20:21] op_sel:[0,1] op_sel_hi:[1,1]
    v_exp_f32 v228, v100
    v_exp_f32 v229, v101
    v_exp_f32 v230, v102
    v_exp_f32 v231, v103
    v_pk_fma_f32 v[232:233], v[228:229], 0.5, 1.0 op_sel_hi:[1,0,0]
    v_pk_fma_f32 v[234:235], v[230:231], 0.5, 1.0 op_sel_hi:[1,0,0]
    v_pk_fma_f32 v[232:233], v[228:229], v[232:233], 1.0 op_sel_hi:[1,1,0]
    v_pk_fma_f32 v[234:235], v[230:231], v[234:235], 1.0 op_sel_hi:[1,1,0]
    v_rcp_f32 v232, v232
    v_rcp_f32 v233, v233
    v_rcp_f32 v234, v234
    v_rcp_f32 v235, v235
    v_pk_fma_f32 v[100:101], v[100:101], v[232:233], v[100:101] neg_lo:[1,0,0] neg_hi:[1,0,0]
    v_pk_fma_f32 v[102:103], v[102:103], v[234:235], v[102:103] neg_lo:[1,0,0] neg_hi:[1,0,0]
    v_cvt_pk_bf16_f32 v212, v100, v101
    v_cvt_pk_bf16_f32 v213, v102, v103
    v_pk_mul_f32 v[108:109], v[108:109], v[20:21] op_sel:[0,1] op_sel_hi:[1,1]
    v_pk_mul_f32 v[110:111], v[110:111], v[20:21] op_sel:[0,1] op_sel_hi:[1,1]
    v_exp_f32 v228, v108
    v_exp_f32 v229, v109
    v_exp_f32 v230, v110
    v_exp_f32 v231, v111
    v_pk_fma_f32 v[232:233], v[228:229], 0.5, 1.0 op_sel_hi:[1,0,0]
    v_pk_fma_f32 v[234:235], v[230:231], 0.5, 1.0 op_sel_hi:[1,0,0]
    v_pk_fma_f32 v[232:233], v[228:229], v[232:233], 1.0 op_sel_hi:[1,1,0]
    v_pk_fma_f32 v[234:235], v[230:231], v[234:235], 1.0 op_sel_hi:[1,1,0]
    v_rcp_f32 v232, v232
    v_rcp_f32 v233, v233
    v_rcp_f32 v234, v234
    v_rcp_f32 v235, v235
    v_pk_fma_f32 v[108:109], v[108:109], v[232:233], v[108:109] neg_lo:[1,0,0] neg_hi:[1,0,0]
    v_pk_fma_f32 v[110:111], v[110:111], v[234:235], v[110:111] neg_lo:[1,0,0] neg_hi:[1,0,0]
    v_cvt_pk_bf16_f32 v214, v108, v109
    v_cvt_pk_bf16_f32 v215, v110, v111
    buffer_store_dwordx4 v[212:215], v225, s[16:19], s74 offen sc1
    v_pk_mul_f32 v[112:113], v[112:113], v[20:21] op_sel_hi:[1,0]
    v_pk_mul_f32 v[114:115], v[114:115], v[20:21] op_sel_hi:[1,0]
    v_exp_f32 v228, v112
    v_exp_f32 v229, v113
    v_exp_f32 v230, v114
    v_exp_f32 v231, v115
    v_pk_fma_f32 v[232:233], v[228:229], 0.5, 1.0 op_sel_hi:[1,0,0]
    v_pk_fma_f32 v[234:235], v[230:231], 0.5, 1.0 op_sel_hi:[1,0,0]
    v_pk_fma_f32 v[232:233], v[228:229], v[232:233], 1.0 op_sel_hi:[1,1,0]
    v_pk_fma_f32 v[234:235], v[230:231], v[234:235], 1.0 op_sel_hi:[1,1,0]
    v_rcp_f32 v232, v232
    v_rcp_f32 v233, v233
    v_rcp_f32 v234, v234
    v_rcp_f32 v235, v235
    v_pk_fma_f32 v[112:113], v[112:113], v[232:233], v[112:113] neg_lo:[1,0,0] neg_hi:[1,0,0]
    v_pk_fma_f32 v[114:115], v[114:115], v[234:235], v[114:115] neg_lo:[1,0,0] neg_hi:[1,0,0]
    v_cvt_pk_bf16_f32 v216, v112, v113
    v_cvt_pk_bf16_f32 v217, v114, v115
    v_pk_mul_f32 v[120:121], v[120:121], v[20:21] op_sel_hi:[1,0]
    v_pk_mul_f32 v[122:123], v[122:123], v[20:21] op_sel_hi:[1,0]
    v_exp_f32 v228, v120
    v_exp_f32 v229, v121
    v_exp_f32 v230, v122
    v_exp_f32 v231, v123
    v_pk_fma_f32 v[232:233], v[228:229], 0.5, 1.0 op_sel_hi:[1,0,0]
    v_pk_fma_f32 v[234:235], v[230:231], 0.5, 1.0 op_sel_hi:[1,0,0]
    v_pk_fma_f32 v[232:233], v[228:229], v[232:233], 1.0 op_sel_hi:[1,1,0]
    v_pk_fma_f32 v[234:235], v[230:231], v[234:235], 1.0 op_sel_hi:[1,1,0]
    v_rcp_f32 v232, v232
    v_rcp_f32 v233, v233
    v_rcp_f32 v234, v234
    v_rcp_f32 v235, v235
    v_pk_fma_f32 v[120:121], v[120:121], v[232:233], v[120:121] neg_lo:[1,0,0] neg_hi:[1,0,0]
    v_pk_fma_f32 v[122:123], v[122:123], v[234:235], v[122:123] neg_lo:[1,0,0] neg_hi:[1,0,0]
    v_cvt_pk_bf16_f32 v218, v120, v121
    v_cvt_pk_bf16_f32 v219, v122, v123
    buffer_store_dwordx4 v[216:219], v226, s[16:19], s74 offen sc1
    v_pk_mul_f32 v[116:117], v[116:117], v[20:21] op_sel:[0,1] op_sel_hi:[1,1]
    v_pk_mul_f32 v[118:119], v[118:119], v[20:21] op_sel:[0,1] op_sel_hi:[1,1]
    v_exp_f32 v228, v116
    v_exp_f32 v229, v117
    v_exp_f32 v230, v118
    v_exp_f32 v231, v119
    v_pk_fma_f32 v[232:233], v[228:229], 0.5, 1.0 op_sel_hi:[1,0,0]
    v_pk_fma_f32 v[234:235], v[230:231], 0.5, 1.0 op_sel_hi:[1,0,0]
    v_pk_fma_f32 v[232:233], v[228:229], v[232:233], 1.0 op_sel_hi:[1,1,0]
    v_pk_fma_f32 v[234:235], v[230:231], v[234:235], 1.0 op_sel_hi:[1,1,0]
    v_rcp_f32 v232, v232
    v_rcp_f32 v233, v233
    v_rcp_f32 v234, v234
    v_rcp_f32 v235, v235
    v_pk_fma_f32 v[116:117], v[116:117], v[232:233], v[116:117] neg_lo:[1,0,0] neg_hi:[1,0,0]
    v_pk_fma_f32 v[118:119], v[118:119], v[234:235], v[118:119] neg_lo:[1,0,0] neg_hi:[1,0,0]
    v_cvt_pk_bf16_f32 v220, v116, v117
    v_cvt_pk_bf16_f32 v221, v118, v119
    v_pk_mul_f32 v[124:125], v[124:125], v[20:21] op_sel:[0,1] op_sel_hi:[1,1]
    v_pk_mul_f32 v[126:127], v[126:127], v[20:21] op_sel:[0,1] op_sel_hi:[1,1]
    v_exp_f32 v228, v124
    v_exp_f32 v229, v125
    v_exp_f32 v230, v126
    v_exp_f32 v231, v127
    v_pk_fma_f32 v[232:233], v[228:229], 0.5, 1.0 op_sel_hi:[1,0,0]
    v_pk_fma_f32 v[234:235], v[230:231], 0.5, 1.0 op_sel_hi:[1,0,0]
    v_pk_fma_f32 v[232:233], v[228:229], v[232:233], 1.0 op_sel_hi:[1,1,0]
    v_pk_fma_f32 v[234:235], v[230:231], v[234:235], 1.0 op_sel_hi:[1,1,0]
    v_rcp_f32 v232, v232
    v_rcp_f32 v233, v233
    v_rcp_f32 v234, v234
    v_rcp_f32 v235, v235
    v_pk_fma_f32 v[124:125], v[124:125], v[232:233], v[124:125] neg_lo:[1,0,0] neg_hi:[1,0,0]
    v_pk_fma_f32 v[126:127], v[126:127], v[234:235], v[126:127] neg_lo:[1,0,0] neg_hi:[1,0,0]
    v_cvt_pk_bf16_f32 v222, v124, v125
    v_cvt_pk_bf16_f32 v223, v126, v127
    buffer_store_dwordx4 v[220:223], v227, s[16:19], s74 offen sc1
L_join_11:
    s_lshl_b32 s85, s33, 13
    s_add_u32 s20, s85, 98304
    v_lshrrev_b32 v2, 2, v0
    v_bfe_u32 v3, v0, 3, 2
    v_lshlrev_b32 v2, 7, v2
    v_lshl_add_u32 v2, v3, 5, v2
    v_and_b32 v3, 3, v0
    v_lshl_add_u32 v2, v3, 3, v2
    v_add_u32 v60, s20, v2
    v_xor_b32 v61, 32, v60
    v_xor_b32 v62, 64, v60
    v_xor_b32 v63, 96, v60
    s_lshl_b32 s72, s32, 7
    v_lshrrev_b32 v2, 4, v0
    v_and_b32 v3, 7, v0
    v_lshlrev_b32 v2, 1, v2
    v_xor_b32 v2, v2, v3
    v_lshlrev_b32 v2, 4, v2
    v_lshrrev_b32 v3, 3, v0
    v_lshl_add_u32 v64, v3, 10, v2
    v_add_u32 v65, 7168, v64
    v_add_u32 v66, 14336, v64
    v_add_u32 v67, 21504, v64
    s_mul_i32 s20, s33, 7
    s_and_b32 s68, s31, 1
    s_and_b32 s21, s32, 0
    s_lshl1_add_u32 s22, s21, s87
    s_add_u32 s23, s22, 0
    s_and_b32 s23, s23, 3
    s_lshl1_add_u32 s23, s23, s68
    s_min_u32 s23, s23, 6
    s_add_u32 s78, s23, s20
    s_add_u32 s23, s22, 1
    s_and_b32 s23, s23, 3
    s_lshl1_add_u32 s23, s23, s68
    s_min_u32 s23, s23, 6
    s_add_u32 s79, s23, s20
    s_add_u32 s23, s22, 2
    s_and_b32 s23, s23, 3
    s_lshl1_add_u32 s23, s23, s68
    s_min_u32 s23, s23, 6
    s_add_u32 s80, s23, s20
    s_add_u32 s23, s22, 3
    s_and_b32 s23, s23, 3
    s_lshl1_add_u32 s23, s23, s68
    s_min_u32 s23, s23, 6
    s_add_u32 s81, s23, s20
    s_add_u32 s21, s21, s87
    s_mul_i32 s22, s21, 86
    s_lshr_b32 s22, s22, 8
    s_mul_i32 s22, s22, 3
    s_sub_u32 s21, s21, s22
    s_add_u32 s20, s20, 1
    s_sub_u32 s20, s20, s68
    s_lshl1_add_u32 s82, s21, s20
    s_add_u32 s21, s21, 1
    s_cmp_eq_u32 s21, 3
    s_cselect_b32 s21, 0, s21
    s_lshl1_add_u32 s83, s21, s20
    s_add_u32 s21, s21, 1
    s_cmp_eq_u32 s21, 3
    s_cselect_b32 s21, 0, s21
    s_lshl1_add_u32 s84, s21, s20
    s_add_u32 s21, s21, 1
    s_cmp_eq_u32 s21, 3
    s_cselect_b32 s21, 0, s21
    s_mov_b32 s4, s60
    s_mov_b32 s5, s61
    s_mov_b32 s6, 1835008
    s_mov_b32 s7, 0x00020000
    s_mul_i32 s20, s31, 12
    s_lshl1_add_u32 s20, s33, s20
    s_add_u32 s20, s20, 4
    s_lshl_b32 s20, s20, 7
    s_add_u32 s20, s20, 1048576
    s_add_u32 s42, s66, s20
    s_addc_u32 s43, s67, 0
    v_readfirstlane_b32 s40, v1
    v_readfirstlane_b32 s41, v1
    s_waitcnt vmcnt(4)
    s_cmp_ge_u32 s70, 6
    s_cbranch_scc1 L_light_12
L_heavy_13:
    s_add_u32 s20, s75, 1048576
    s_mov_b64 exec, 1
    buffer_store_dword v1, off, s[16:19], s20 sc1
    s_mov_b64 exec, -1
    s_waitcnt vmcnt(1)
    s_add_u32 s20, s75, 1048704
    s_mov_b64 exec, 1
    buffer_store_dword v1, off, s[16:19], s20 sc1
    s_mov_b64 exec, -1
    s_setprio 0
    s_barrier
    ds_read_b64_tr_b16 v[128:129], v60 offset:0
    ds_read_b64_tr_b16 v[130:131], v60 offset:2048
    ds_read_b64_tr_b16 v[132:133], v61 offset:0
    ds_read_b64_tr_b16 v[134:135], v61 offset:2048
    ds_read_b64_tr_b16 v[136:137], v62 offset:0
    ds_read_b64_tr_b16 v[138:139], v62 offset:2048
    ds_read_b64_tr_b16 v[140:141], v63 offset:0
    ds_read_b64_tr_b16 v[142:143], v63 offset:2048
    ds_read_b64_tr_b16 v[144:145], v60 offset:4096
    ds_read_b64_tr_b16 v[146:147], v60 offset:6144
    ds_read_b64_tr_b16 v[148:149], v61 offset:4096
    ds_read_b64_tr_b16 v[150:151], v61 offset:6144
    ds_read_b64_tr_b16 v[152:153], v62 offset:4096
    ds_read_b64_tr_b16 v[154:155], v62 offset:6144
    ds_read_b64_tr_b16 v[156:157], v63 offset:4096
    ds_read_b64_tr_b16 v[158:159], v63 offset:6144
    ds_read_b64_tr_b16 v[160:161], v60 offset:32768
    ds_read_b64_tr_b16 v[162:163], v60 offset:34816
    ds_read_b64_tr_b16 v[164:165], v61 offset:32768
    ds_read_b64_tr_b16 v[166:167], v61 offset:34816
    ds_read_b64_tr_b16 v[168:169], v62 offset:32768
    ds_read_b64_tr_b16 v[170:171], v62 offset:34816
    ds_read_b64_tr_b16 v[172:173], v63 offset:32768
    ds_read_b64_tr_b16 v[174:175], v63 offset:34816
    ds_read_b64_tr_b16 v[176:177], v60 offset:36864
    ds_read_b64_tr_b16 v[178:179], v60 offset:38912
    ds_read_b64_tr_b16 v[180:181], v61 offset:36864
    ds_read_b64_tr_b16 v[182:183], v61 offset:38912
    ds_read_b64_tr_b16 v[184:185], v62 offset:36864
    ds_read_b64_tr_b16 v[186:187], v62 offset:38912
    ds_read_b64_tr_b16 v[188:189], v63 offset:36864
    ds_read_b64_tr_b16 v[190:191], v63 offset:38912
    v_subrev_u32 v60, 32768, v60
    v_subrev_u32 v61, 32768, v61
    v_subrev_u32 v62, 32768, v62
    v_subrev_u32 v63, 32768, v63
    ds_read_b64_tr_b16 v[192:193], v60 offset:0
    ds_read_b64_tr_b16 v[194:195], v60 offset:2048
    ds_read_b64_tr_b16 v[196:197], v61 offset:0
    ds_read_b64_tr_b16 v[198:199], v61 offset:2048
    ds_read_b64_tr_b16 v[200:201], v62 offset:0
    ds_read_b64_tr_b16 v[202:203], v62 offset:2048
    ds_read_b64_tr_b16 v[204:205], v63 offset:0
    ds_read_b64_tr_b16 v[206:207], v63 offset:2048
    ds_read_b64_tr_b16 v[208:209], v60 offset:4096
    ds_read_b64_tr_b16 v[210:211], v60 offset:6144
    ds_read_b64_tr_b16 v[212:213], v61 offset:4096
    ds_read_b64_tr_b16 v[214:215], v61 offset:6144
    ds_read_b64_tr_b16 v[216:217], v62 offset:4096
    ds_read_b64_tr_b16 v[218:219], v62 offset:6144
    ds_read_b64_tr_b16 v[220:221], v63 offset:4096
    ds_read_b64_tr_b16 v[222:223], v63 offset:6144
    v_subrev_u32 v60, 65536, v60
    v_subrev_u32 v61, 65536, v61
    v_subrev_u32 v62, 65536, v62
    v_subrev_u32 v63, 65536, v63
    ds_read_b64_tr_b16 v[224:225], v60 offset:0
    ds_read_b64_tr_b16 v[226:227], v60 offset:2048
    ds_read_b64_tr_b16 v[228:229], v61 offset:0
    ds_read_b64_tr_b16 v[230:231], v61 offset:2048
    ds_read_b64_tr_b16 v[232:233], v62 offset:0
    ds_read_b64_tr_b16 v[234:235], v62 offset:2048
    ds_read_b64_tr_b16 v[236:237], v63 offset:0
    ds_read_b64_tr_b16 v[238:239], v63 offset:2048
    ds_read_b64_tr_b16 v[240:241], v60 offset:4096
    ds_read_b64_tr_b16 v[242:243], v60 offset:6144
    ds_read_b64_tr_b16 v[244:245], v61 offset:4096
    ds_read_b64_tr_b16 v[246:247], v61 offset:6144
    ds_read_b64_tr_b16 v[248:249], v62 offset:4096
    ds_read_b64_tr_b16 v[250:251], v62 offset:6144
    ds_read_b64_tr_b16 v[252:253], v63 offset:4096
    ds_read_b64_tr_b16 v[254:255], v63 offset:6144
    s_waitcnt lgkmcnt(0)
    s_load_dwordx8 s[8:15], s[42:43], 0 glc
    s_lshl_b32 s71, s83, 16
    s_add_u32 s71, s71, s72
    s_lshl_b32 s74, s84, 16
    s_add_u32 s74, s74, s72
    s_add_u32 m0, s85, 0
    s_add_u32 s71, s71, 0
    buffer_load_dwordx4 v64, s[4:7], s71 offen lds
    buffer_load_dwordx4 v65, s[4:7], s71 offen offset:1024 lds
    buffer_load_dwordx4 v66, s[4:7], s71 offen offset:2048 lds
    buffer_load_dwordx4 v67, s[4:7], s71 offen offset:3072 lds
    s_add_u32 m0, s85, 4096
    s_add_u32 s71, s71, 32768
    buffer_load_dwordx4 v64, s[4:7], s71 offen lds
    buffer_load_dwordx4 v65, s[4:7], s71 offen offset:1024 lds
    buffer_load_dwordx4 v66, s[4:7], s71 offen offset:2048 lds
    buffer_load_dwordx4 v67, s[4:7], s71 offen offset:3072 lds
    s_add_u32 m0, s85, 65536
    s_add_u32 s74, s74, 0
    buffer_load_dwordx4 v64, s[4:7], s74 offen lds
    buffer_load_dwordx4 v65, s[4:7], s74 offen offset:1024 lds
    buffer_load_dwordx4 v66, s[4:7], s74 offen offset:2048 lds
    buffer_load_dwordx4 v67, s[4:7], s74 offen offset:3072 lds
    s_add_u32 m0, s85, 69632
    s_add_u32 s74, s74, 32768
    buffer_load_dwordx4 v64, s[4:7], s74 offen lds
    buffer_load_dwordx4 v65, s[4:7], s74 offen offset:1024 lds
    buffer_load_dwordx4 v66, s[4:7], s74 offen offset:2048 lds
    buffer_load_dwordx4 v67, s[4:7], s74 offen offset:3072 lds
    s_add_u32 s21, s86, 131072
    s_lshl_b32 s78, s78, 13
    s_add_u32 s78, s78, s21
    s_lshl_b32 s79, s79, 13
    s_add_u32 s79, s79, s21
    s_lshl_b32 s80, s80, 13
    s_add_u32 s80, s80, s21
    s_lshl_b32 s81, s81, 13
    s_add_u32 s81, s81, s21
    s_lshl_b32 s82, s82, 13
    s_add_u32 s82, s82, s21
    s_lshl_b32 s83, s83, 13
    s_add_u32 s83, s83, s21
    s_lshl_b32 s84, s84, 13
    s_add_u32 s84, s84, s21
L_chk_14:
    s_waitcnt lgkmcnt(0)
    s_xor_b64 s[8:9], s[8:9], s[40:41]
    s_xor_b64 s[10:11], s[10:11], s[40:41]
    s_xor_b64 s[12:13], s[12:13], s[40:41]
    s_xor_b64 s[14:15], s[14:15], s[40:41]
    s_or_b64 s[8:9], s[8:9], s[10:11]
    s_or_b64 s[12:13], s[12:13], s[14:15]
    s_or_b64 s[8:9], s[8:9], s[12:13]
    s_cbranch_scc1 L_retry_16
L_ok_15:
    s_barrier
    buffer_load_dwordx4 v[8:11], v6, s[16:19], s78 offen sc1
    buffer_load_dwordx4 v[12:15], v6, s[16:19], s78 offen offset:1024 sc1
    buffer_load_dwordx4 v[16:19], v6, s[16:19], s78 offen offset:2048 sc1
    buffer_load_dwordx4 v[20:23], v6, s[16:19], s78 offen offset:3072 sc1
    buffer_load_dwordx4 v[24:27], v7, s[16:19], s78 offen offset:1024 sc1
    buffer_load_dwordx4 v[28:31], v7, s[16:19], s78 offen sc1
    buffer_load_dwordx4 v[32:35], v7, s[16:19], s78 offen offset:3072 sc1
    s_waitcnt vmcnt(6)
    v_mfma_f32_16x16x32_bf16 v[64:67], v[128:131], v[8:11], 0
    buffer_load_dwordx4 v[36:39], v7, s[16:19], s78 offen offset:2048 sc1
    v_mfma_f32_16x16x32_bf16 v[68:71], v[132:135], v[8:11], 0
    v_mfma_f32_16x16x32_bf16 v[72:75], v[136:139], v[8:11], 0
    buffer_load_dwordx4 v[40:43], v6, s[16:19], s79 offen sc1
    v_mfma_f32_16x16x32_bf16 v[76:79], v[140:143], v[8:11], 0
    s_waitcnt vmcnt(7)
    v_mfma_f32_16x16x32_bf16 v[80:83], v[128:131], v[12:15], 0
    buffer_load_dwordx4 v[44:47], v6, s[16:19], s79 offen offset:1024 sc1
    v_mfma_f32_16x16x32_bf16 v[84:87], v[132:135], v[12:15], 0
    v_mfma_f32_16x16x32_bf16 v[88:91], v[136:139], v[12:15], 0
    buffer_load_dwordx4 v[48:51], v6, s[16:19], s79 offen offset:2048 sc1
    v_mfma_f32_16x16x32_bf16 v[92:95], v[140:143], v[12:15], 0
    s_waitcnt vmcnt(8)
    v_mfma_f32_16x16x32_bf16 v[96:99], v[128:131], v[16:19], 0
    buffer_load_dwordx4 v[52:55], v6, s[16:19], s79 offen offset:3072 sc1
    v_mfma_f32_16x16x32_bf16 v[100:103], v[132:135], v[16:19], 0
    v_mfma_f32_16x16x32_bf16 v[104:107], v[136:139], v[16:19], 0
    buffer_load_dwordx4 v[56:59], v7, s[16:19], s79 offen offset:1024 sc1
    v_mfma_f32_16x16x32_bf16 v[108:111], v[140:143], v[16:19], 0
    s_waitcnt vmcnt(9)
    v_mfma_f32_16x16x32_bf16 v[112:115], v[128:131], v[20:23], 0
    buffer_load_dwordx4 v[8:11], v7, s[16:19], s79 offen sc1
    v_mfma_f32_16x16x32_bf16 v[116:119], v[132:135], v[20:23], 0
    v_mfma_f32_16x16x32_bf16 v[120:123], v[136:139], v[20:23], 0
    v_mfma_f32_16x16x32_bf16 v[124:127], v[140:143], v[20:23], 0
    s_waitcnt vmcnt(9)
    v_mfma_f32_16x16x32_bf16 v[64:67], v[144:147], v[24:27], v[64:67]
    buffer_load_dwordx4 v[12:15], v7, s[16:19], s79 offen offset:3072 sc1
    v_mfma_f32_16x16x32_bf16 v[68:71], v[148:151], v[24:27], v[68:71]
    v_mfma_f32_16x16x32_bf16 v[72:75], v[152:155], v[24:27], v[72:75]
    v_mfma_f32_16x16x32_bf16 v[76:79], v[156:159], v[24:27], v[76:79]
    s_waitcnt vmcnt(9)
    v_mfma_f32_16x16x32_bf16 v[80:83], v[144:147], v[28:31], v[80:83]
    buffer_load_dwordx4 v[16:19], v7, s[16:19], s79 offen offset:2048 sc1
    v_mfma_f32_16x16x32_bf16 v[84:87], v[148:151], v[28:31], v[84:87]
    ds_read_b64_tr_b16 v[128:129], v60 offset:32768
    v_mfma_f32_16x16x32_bf16 v[88:91], v[152:155], v[28:31], v[88:91]
    ds_read_b64_tr_b16 v[130:131], v60 offset:34816
    v_mfma_f32_16x16x32_bf16 v[92:95], v[156:159], v[28:31], v[92:95]
    s_waitcnt vmcnt(9)
    v_mfma_f32_16x16x32_bf16 v[96:99], v[144:147], v[32:35], v[96:99]
    buffer_load_dwordx4 v[20:23], v6, s[16:19], s80 offen sc1
    v_mfma_f32_16x16x32_bf16 v[100:103], v[148:151], v[32:35], v[100:103]
    ds_read_b64_tr_b16 v[132:133], v61 offset:32768
    v_mfma_f32_16x16x32_bf16 v[104:107], v[152:155], v[32:35], v[104:107]
    ds_read_b64_tr_b16 v[134:135], v61 offset:34816
    v_mfma_f32_16x16x32_bf16 v[108:111], v[156:159], v[32:35], v[108:111]
    s_waitcnt vmcnt(9)
    v_mfma_f32_16x16x32_bf16 v[112:115], v[144:147], v[36:39], v[112:115]
    buffer_load_dwordx4 v[24:27], v6, s[16:19], s80 offen offset:1024 sc1
    v_mfma_f32_16x16x32_bf16 v[116:119], v[148:151], v[36:39], v[116:119]
    ds_read_b64_tr_b16 v[136:137], v62 offset:32768
    v_mfma_f32_16x16x32_bf16 v[120:123], v[152:155], v[36:39], v[120:123]
    ds_read_b64_tr_b16 v[138:139], v62 offset:34816
    v_mfma_f32_16x16x32_bf16 v[124:127], v[156:159], v[36:39], v[124:127]
    s_waitcnt vmcnt(9)
    v_mfma_f32_16x16x32_bf16 v[64:67], v[160:163], v[40:43], v[64:67]
    buffer_load_dwordx4 v[28:31], v6, s[16:19], s80 offen offset:2048 sc1
    v_mfma_f32_16x16x32_bf16 v[68:71], v[164:167], v[40:43], v[68:71]
    ds_read_b64_tr_b16 v[140:141], v63 offset:32768
    v_mfma_f32_16x16x32_bf16 v[72:75], v[168:171], v[40:43], v[72:75]
    ds_read_b64_tr_b16 v[142:143], v63 offset:34816
    v_mfma_f32_16x16x32_bf16 v[76:79], v[172:175], v[40:43], v[76:79]
    s_waitcnt vmcnt(9)
    v_mfma_f32_16x16x32_bf16 v[80:83], v[160:163], v[44:47], v[80:83]
    buffer_load_dwordx4 v[32:35], v6, s[16:19], s80 offen offset:3072 sc1
    v_mfma_f32_16x16x32_bf16 v[84:87], v[164:167], v[44:47], v[84:87]
    ds_read_b64_tr_b16 v[144:145], v60 offset:36864
    v_mfma_f32_16x16x32_bf16 v[88:91], v[168:171], v[44:47], v[88:91]
    ds_read_b64_tr_b16 v[146:147], v60 offset:38912
    v_mfma_f32_16x16x32_bf16 v[92:95], v[172:175], v[44:47], v[92:95]
    s_waitcnt vmcnt(9)
    v_mfma_f32_16x16x32_bf16 v[96:99], v[160:163], v[48:51], v[96:99]
    buffer_load_dwordx4 v[36:39], v7, s[16:19], s80 offen offset:1024 sc1
    v_mfma_f32_16x16x32_bf16 v[100:103], v[164:167], v[48:51], v[100:103]
    ds_read_b64_tr_b16 v[148:149], v61 offset:36864
    v_mfma_f32_16x16x32_bf16 v[104:107], v[168:171], v[48:51], v[104:107]
    ds_read_b64_tr_b16 v[150:151], v61 offset:38912
    v_mfma_f32_16x16x32_bf16 v[108:111], v[172:175], v[48:51], v[108:111]
    s_waitcnt vmcnt(9)
    v_mfma_f32_16x16x32_bf16 v[112:115], v[160:163], v[52:55], v[112:115]
    buffer_load_dwordx4 v[40:43], v7, s[16:19], s80 offen sc1
    v_mfma_f32_16x16x32_bf16 v[116:119], v[164:167], v[52:55], v[116:119]
    ds_read_b64_tr_b16 v[152:153], v62 offset:36864
    v_mfma_f32_16x16x32_bf16 v[120:123], v[168:171], v[52:55], v[120:123]
    ds_read_b64_tr_b16 v[154:155], v62 offset:38912
    v_mfma_f32_16x16x32_bf16 v[124:127], v[172:175], v[52:55], v[124:127]
    s_waitcnt vmcnt(9)
    v_mfma_f32_16x16x32_bf16 v[64:67], v[176:179], v[56:59], v[64:67]
    s_load_dwordx8 s[8:15], s[42:43], 128 glc
    buffer_load_dwordx4 v[44:47], v7, s[16:19], s80 offen offset:3072 sc1
    v_mfma_f32_16x16x32_bf16 v[68:71], v[180:183], v[56:59], v[68:71]
    ds_read_b64_tr_b16 v[156:157], v63 offset:36864
    v_mfma_f32_16x16x32_bf16 v[72:75], v[184:187], v[56:59], v[72:75]
    ds_read_b64_tr_b16 v[158:159], v63 offset:38912
    v_mfma_f32_16x16x32_bf16 v[76:79], v[188:191], v[56:59], v[76:79]
    s_waitcnt vmcnt(9)
    v_mfma_f32_16x16x32_bf16 v[80:83], v[176:179], v[8:11], v[80:83]
    buffer_load_dwordx4 v[48:51], v7, s[16:19], s80 offen offset:2048 sc1
    v_mfma_f32_16x16x32_bf16 v[84:87], v[180:183], v[8:11], v[84:87]
    v_mfma_f32_16x16x32_bf16 v[88:91], v[184:187], v[8:11], v[88:91]
    ds_read_b64_tr_b16 v[160:161], v60 offset:0
    v_mfma_f32_16x16x32_bf16 v[92:95], v[188:191], v[8:11], v[92:95]
    s_waitcnt vmcnt(9)
    v_mfma_f32_16x16x32_bf16 v[96:99], v[176:179], v[12:15], v[96:99]
    buffer_load_dwordx4 v[52:55], v6, s[16:19], s81 offen sc1
    v_mfma_f32_16x16x32_bf16 v[100:103], v[180:183], v[12:15], v[100:103]
    ds_read_b64_tr_b16 v[162:163], v60 offset:2048
    v_mfma_f32_16x16x32_bf16 v[104:107], v[184:187], v[12:15], v[104:107]
    ds_read_b64_tr_b16 v[164:165], v61 offset:0
    v_mfma_f32_16x16x32_bf16 v[108:111], v[188:191], v[12:15], v[108:111]
    s_waitcnt vmcnt(9)
    v_mfma_f32_16x16x32_bf16 v[112:115], v[176:179], v[16:19], v[112:115]
    buffer_load_dwordx4 v[56:59], v6, s[16:19], s81 offen offset:1024 sc1
    v_mfma_f32_16x16x32_bf16 v[116:119], v[180:183], v[16:19], v[116:119]
    ds_read_b64_tr_b16 v[166:167], v61 offset:2048
    v_mfma_f32_16x16x32_bf16 v[120:123], v[184:187], v[16:19], v[120:123]
    ds_read_b64_tr_b16 v[168:169], v62 offset:0
    v_mfma_f32_16x16x32_bf16 v[124:127], v[188:191], v[16:19], v[124:127]
    s_waitcnt vmcnt(9)
    v_mfma_f32_16x16x32_bf16 v[64:67], v[192:195], v[20:23], v[64:67]
    buffer_load_dwordx4 v[8:11], v6, s[16:19], s81 offen offset:2048 sc1
    v_mfma_f32_16x16x32_bf16 v[68:71], v[196:199], v[20:23], v[68:71]
    ds_read_b64_tr_b16 v[170:171], v62 offset:2048
    v_mfma_f32_16x16x32_bf16 v[72:75], v[200:203], v[20:23], v[72:75]
    ds_read_b64_tr_b16 v[172:173], v63 offset:0
    v_mfma_f32_16x16x32_bf16 v[76:79], v[204:207], v[20:23], v[76:79]
    s_waitcnt vmcnt(9)
    v_mfma_f32_16x16x32_bf16 v[80:83], v[192:195], v[24:27], v[80:83]
    buffer_load_dwordx4 v[12:15], v6, s[16:19], s81 offen offset:3072 sc1
    v_mfma_f32_16x16x32_bf16 v[84:87], v[196:199], v[24:27], v[84:87]
    ds_read_b64_tr_b16 v[174:175], v63 offset:2048
    v_mfma_f32_16x16x32_bf16 v[88:91], v[200:203], v[24:27], v[88:91]
    v_mfma_f32_16x16x32_bf16 v[92:95], v[204:207], v[24:27], v[92:95]
    s_waitcnt vmcnt(9)
    v_mfma_f32_16x16x32_bf16 v[96:99], v[192:195], v[28:31], v[96:99]
    buffer_load_dwordx4 v[16:19], v7, s[16:19], s81 offen offset:1024 sc1
    v_mfma_f32_16x16x32_bf16 v[100:103], v[196:199], v[28:31], v[100:103]
    ds_read_b64_tr_b16 v[176:177], v60 offset:4096
    v_mfma_f32_16x16x32_bf16 v[104:107], v[200:203], v[28:31], v[104:107]
    ds_read_b64_tr_b16 v[178:179], v60 offset:6144
    v_mfma_f32_16x16x32_bf16 v[108:111], v[204:207], v[28:31], v[108:111]
    s_waitcnt vmcnt(9)
    v_mfma_f32_16x16x32_bf16 v[112:115], v[192:195], v[32:35], v[112:115]
    buffer_load_dwordx4 v[20:23], v7, s[16:19], s81 offen sc1
    v_mfma_f32_16x16x32_bf16 v[116:119], v[196:199], v[32:35], v[116:119]
    ds_read_b64_tr_b16 v[180:181], v61 offset:4096
    v_mfma_f32_16x16x32_bf16 v[120:123], v[200:203], v[32:35], v[120:123]
    ds_read_b64_tr_b16 v[182:183], v61 offset:6144
    v_mfma_f32_16x16x32_bf16 v[124:127], v[204:207], v[32:35], v[124:127]
    s_waitcnt vmcnt(9)
    v_mfma_f32_16x16x32_bf16 v[64:67], v[208:211], v[36:39], v[64:67]
    buffer_load_dwordx4 v[24:27], v7, s[16:19], s81 offen offset:3072 sc1
    v_mfma_f32_16x16x32_bf16 v[68:71], v[212:215], v[36:39], v[68:71]
    ds_read_b64_tr_b16 v[184:185], v62 offset:4096
    v_mfma_f32_16x16x32_bf16 v[72:75], v[216:219], v[36:39], v[72:75]
    ds_read_b64_tr_b16 v[186:187], v62 offset:6144
    v_mfma_f32_16x16x32_bf16 v[76:79], v[220:223], v[36:39], v[76:79]
    s_waitcnt vmcnt(9)
    v_mfma_f32_16x16x32_bf16 v[80:83], v[208:211], v[40:43], v[80:83]
    buffer_load_dwordx4 v[28:31], v7, s[16:19], s81 offen offset:2048 sc1
    v_mfma_f32_16x16x32_bf16 v[84:87], v[212:215], v[40:43], v[84:87]
    ds_read_b64_tr_b16 v[188:189], v63 offset:4096
    v_mfma_f32_16x16x32_bf16 v[88:91], v[216:219], v[40:43], v[88:91]
    ds_read_b64_tr_b16 v[190:191], v63 offset:6144
    v_mfma_f32_16x16x32_bf16 v[92:95], v[220:223], v[40:43], v[92:95]
    s_waitcnt vmcnt(9)
    v_mfma_f32_16x16x32_bf16 v[96:99], v[208:211], v[44:47], v[96:99]
L_chk_17:
    s_waitcnt lgkmcnt(0)
    s_xor_b64 s[8:9], s[8:9], s[40:41]
    s_xor_b64 s[10:11], s[10:11], s[40:41]
    s_xor_b64 s[12:13], s[12:13], s[40:41]
    s_xor_b64 s[14:15], s[14:15], s[40:41]
    s_or_b64 s[8:9], s[8:9], s[10:11]
    s_or_b64 s[12:13], s[12:13], s[14:15]
    s_or_b64 s[8:9], s[8:9], s[12:13]
    s_cbranch_scc1 L_retry_19
L_ok_18:
    buffer_load_dwordx4 v[32:35], v6, s[16:19], s82 offen sc1
    v_mfma_f32_16x16x32_bf16 v[100:103], v[212:215], v[44:47], v[100:103]
    v_mfma_f32_16x16x32_bf16 v[104:107], v[216:219], v[44:47], v[104:107]
    v_add_u32 v60, 65536, v60
    v_add_u32 v61, 65536, v61
    v_add_u32 v62, 65536, v62
    v_add_u32 v63, 65536, v63
    ds_read_b64_tr_b16 v[192:193], v60 offset:0
    v_mfma_f32_16x16x32_bf16 v[108:111], v[220:223], v[44:47], v[108:111]
    s_waitcnt vmcnt(9)
    v_mfma_f32_16x16x32_bf16 v[112:115], v[208:211], v[48:51], v[112:115]
    buffer_load_dwordx4 v[36:39], v7, s[16:19], s82 offen offset:1024 sc1
    v_mfma_f32_16x16x32_bf16 v[116:119], v[212:215], v[48:51], v[116:119]
    ds_read_b64_tr_b16 v[194:195], v60 offset:2048
    v_mfma_f32_16x16x32_bf16 v[120:123], v[216:219], v[48:51], v[120:123]
    ds_read_b64_tr_b16 v[196:197], v61 offset:0
    v_mfma_f32_16x16x32_bf16 v[124:127], v[220:223], v[48:51], v[124:127]
    s_waitcnt vmcnt(9)
    v_mfma_f32_16x16x32_bf16 v[64:67], v[224:227], v[52:55], v[64:67]
    buffer_load_dwordx4 v[40:43], v6, s[16:19], s83 offen sc1
    v_mfma_f32_16x16x32_bf16 v[68:71], v[228:231], v[52:55], v[68:71]
    ds_read_b64_tr_b16 v[198:199], v61 offset:2048
    v_mfma_f32_16x16x32_bf16 v[72:75], v[232:235], v[52:55], v[72:75]
    ds_read_b64_tr_b16 v[200:201], v62 offset:0
    v_mfma_f32_16x16x32_bf16 v[76:79], v[236:239], v[52:55], v[76:79]
    s_waitcnt vmcnt(9)
    v_mfma_f32_16x16x32_bf16 v[80:83], v[224:227], v[56:59], v[80:83]
    buffer_load_dwordx4 v[44:47], v7, s[16:19], s83 offen offset:1024 sc1
    v_mfma_f32_16x16x32_bf16 v[84:87], v[228:231], v[56:59], v[84:87]
    ds_read_b64_tr_b16 v[202:203], v62 offset:2048
    v_mfma_f32_16x16x32_bf16 v[88:91], v[232:235], v[56:59], v[88:91]
    ds_read_b64_tr_b16 v[204:205], v63 offset:0
    v_mfma_f32_16x16x32_bf16 v[92:95], v[236:239], v[56:59], v[92:95]
    s_waitcnt vmcnt(9)
    v_mfma_f32_16x16x32_bf16 v[96:99], v[224:227], v[8:11], v[96:99]
    buffer_load_dwordx4 v[48:51], v6, s[16:19], s84 offen sc1
    v_mfma_f32_16x16x32_bf16 v[100:103], v[228:231], v[8:11], v[100:103]
    ds_read_b64_tr_b16 v[206:207], v63 offset:2048
    v_mfma_f32_16x16x32_bf16 v[104:107], v[232:235], v[8:11], v[104:107]
    v_mfma_f32_16x16x32_bf16 v[108:111], v[236:239], v[8:11], v[108:111]
    s_waitcnt vmcnt(9)
    v_mfma_f32_16x16x32_bf16 v[112:115], v[224:227], v[12:15], v[112:115]
    buffer_load_dwordx4 v[52:55], v7, s[16:19], s84 offen offset:1024 sc1
    v_mfma_f32_16x16x32_bf16 v[116:119], v[228:231], v[12:15], v[116:119]
    ds_read_b64_tr_b16 v[208:209], v60 offset:4096
    v_mfma_f32_16x16x32_bf16 v[120:123], v[232:235], v[12:15], v[120:123]
    ds_read_b64_tr_b16 v[210:211], v60 offset:6144
    v_mfma_f32_16x16x32_bf16 v[124:127], v[236:239], v[12:15], v[124:127]
    s_waitcnt vmcnt(9)
    v_mfma_f32_16x16x32_bf16 v[64:67], v[240:243], v[16:19], v[64:67]
    buffer_load_dwordx4 v[56:59], v6, s[16:19], s82 offen offset:1024 sc1
    v_mfma_f32_16x16x32_bf16 v[68:71], v[244:247], v[16:19], v[68:71]
    ds_read_b64_tr_b16 v[212:213], v61 offset:4096
    v_mfma_f32_16x16x32_bf16 v[72:75], v[248:251], v[16:19], v[72:75]
    ds_read_b64_tr_b16 v[214:215], v61 offset:6144
    v_mfma_f32_16x16x32_bf16 v[76:79], v[252:255], v[16:19], v[76:79]
    s_waitcnt vmcnt(9)
    v_mfma_f32_16x16x32_bf16 v[80:83], v[240:243], v[20:23], v[80:83]
    buffer_load_dwordx4 v[8:11], v7, s[16:19], s82 offen sc1
    v_mfma_f32_16x16x32_bf16 v[84:87], v[244:247], v[20:23], v[84:87]
    ds_read_b64_tr_b16 v[216:217], v62 offset:4096
    v_mfma_f32_16x16x32_bf16 v[88:91], v[248:251], v[20:23], v[88:91]
    ds_read_b64_tr_b16 v[218:219], v62 offset:6144
    v_mfma_f32_16x16x32_bf16 v[92:95], v[252:255], v[20:23], v[92:95]
    s_waitcnt vmcnt(9)
    v_mfma_f32_16x16x32_bf16 v[96:99], v[240:243], v[24:27], v[96:99]
    buffer_load_dwordx4 v[12:15], v6, s[16:19], s83 offen offset:1024 sc1
    v_mfma_f32_16x16x32_bf16 v[100:103], v[244:247], v[24:27], v[100:103]
    ds_read_b64_tr_b16 v[220:221], v63 offset:4096
    v_mfma_f32_16x16x32_bf16 v[104:107], v[248:251], v[24:27], v[104:107]
    ds_read_b64_tr_b16 v[222:223], v63 offset:6144
    v_mfma_f32_16x16x32_bf16 v[108:111], v[252:255], v[24:27], v[108:111]
    s_waitcnt vmcnt(9)
    v_mfma_f32_16x16x32_bf16 v[112:115], v[240:243], v[28:31], v[112:115]
    buffer_load_dwordx4 v[16:19], v7, s[16:19], s83 offen sc1
    v_mfma_f32_16x16x32_bf16 v[116:119], v[244:247], v[28:31], v[116:119]
    s_waitcnt lgkmcnt(0)
    v_mfma_f32_16x16x32_bf16 v[120:123], v[248:251], v[28:31], v[120:123]
    v_mfma_f32_16x16x32_bf16 v[124:127], v[252:255], v[28:31], v[124:127]
    s_barrier
    s_waitcnt vmcnt(9)
    v_mfma_f32_16x16x32_bf16 v[64:67], v[128:131], v[32:35], v[64:67]
    buffer_load_dwordx4 v[20:23], v6, s[16:19], s84 offen offset:1024 sc1
    v_mfma_f32_16x16x32_bf16 v[68:71], v[132:135], v[32:35], v[68:71]
    v_lshrrev_b32 v2, 4, v0
    v_mfma_f32_16x16x32_bf16 v[72:75], v[136:139], v[32:35], v[72:75]
    v_and_b32 v3, 15, v0
    v_mfma_f32_16x16x32_bf16 v[76:79], v[140:143], v[32:35], v[76:79]
    v_xor_b32 v3, v3, v2
    s_waitcnt vmcnt(9)
    v_mfma_f32_16x16x32_bf16 v[64:67], v[144:147], v[36:39], v[64:67]
    buffer_load_dwordx4 v[24:27], v7, s[16:19], s84 offen sc1
    v_mfma_f32_16x16x32_bf16 v[68:71], v[148:151], v[36:39], v[68:71]
    v_lshlrev_b32 v3, 4, v3
    v_mfma_f32_16x16x32_bf16 v[72:75], v[152:155], v[36:39], v[72:75]
    v_lshl_add_u32 v3, v2, 8, v3
    v_mfma_f32_16x16x32_bf16 v[76:79], v[156:159], v[36:39], v[76:79]
    v_add_u32 v60, s85, v3
    s_waitcnt vmcnt(9)
    v_mfma_f32_16x16x32_bf16 v[64:67], v[160:163], v[40:43], v[64:67]
    buffer_load_dwordx4 v[28:31], v6, s[16:19], s82 offen offset:2048 sc1
    v_mfma_f32_16x16x32_bf16 v[68:71], v[164:167], v[40:43], v[68:71]
    v_xor_b32 v61, 64, v60
    v_mfma_f32_16x16x32_bf16 v[72:75], v[168:171], v[40:43], v[72:75]
    v_xor_b32 v62, 128, v60
    v_mfma_f32_16x16x32_bf16 v[76:79], v[172:175], v[40:43], v[76:79]
    v_xor_b32 v63, 192, v60
    s_waitcnt vmcnt(9)
    v_mfma_f32_16x16x32_bf16 v[64:67], v[176:179], v[44:47], v[64:67]
    buffer_load_dwordx4 v[32:35], v7, s[16:19], s82 offen offset:3072 sc1
    v_mfma_f32_16x16x32_bf16 v[68:71], v[180:183], v[44:47], v[68:71]
    v_mfma_f32_16x16x32_bf16 v[72:75], v[184:187], v[44:47], v[72:75]
    v_mfma_f32_16x16x32_bf16 v[76:79], v[188:191], v[44:47], v[76:79]
    s_waitcnt vmcnt(9)
    v_mfma_f32_16x16x32_bf16 v[64:67], v[192:195], v[48:51], v[64:67]
    buffer_load_dwordx4 v[36:39], v6, s[16:19], s83 offen offset:2048 sc1
    v_mfma_f32_16x16x32_bf16 v[68:71], v[196:199], v[48:51], v[68:71]
    v_mfma_f32_16x16x32_bf16 v[72:75], v[200:203], v[48:51], v[72:75]
    v_mfma_f32_16x16x32_bf16 v[76:79], v[204:207], v[48:51], v[76:79]
    s_waitcnt vmcnt(9)
    v_mfma_f32_16x16x32_bf16 v[64:67], v[208:211], v[52:55], v[64:67]
    buffer_load_dwordx4 v[40:43], v7, s[16:19], s83 offen offset:3072 sc1
    v_mfma_f32_16x16x32_bf16 v[68:71], v[212:215], v[52:55], v[68:71]
    v_mfma_f32_16x16x32_bf16 v[72:75], v[216:219], v[52:55], v[72:75]
    v_mfma_f32_16x16x32_bf16 v[76:79], v[220:223], v[52:55], v[76:79]
    s_waitcnt vmcnt(9)
    v_mfma_f32_16x16x32_bf16 v[80:83], v[128:131], v[56:59], v[80:83]
    buffer_load_dwordx4 v[44:47], v6, s[16:19], s84 offen offset:2048 sc1
    v_mfma_f32_16x16x32_bf16 v[84:87], v[132:135], v[56:59], v[84:87]
    v_mfma_f32_16x16x32_bf16 v[88:91], v[136:139], v[56:59], v[88:91]
    v_mfma_f32_16x16x32_bf16 v[92:95], v[140:143], v[56:59], v[92:95]
    s_waitcnt vmcnt(9)
    v_mfma_f32_16x16x32_bf16 v[80:83], v[144:147], v[8:11], v[80:83]
    buffer_load_dwordx4 v[48:51], v7, s[16:19], s84 offen offset:3072 sc1
    v_mfma_f32_16x16x32_bf16 v[84:87], v[148:151], v[8:11], v[84:87]
    ds_write_b128 v60, v[64:67] offset:0
    v_mfma_f32_16x16x32_bf16 v[88:91], v[152:155], v[8:11], v[88:91]
    ds_write_b128 v61, v[68:71] offset:1024
    v_mfma_f32_16x16x32_bf16 v[92:95], v[156:159], v[8:11], v[92:95]
    s_waitcnt vmcnt(9)
    v_mfma_f32_16x16x32_bf16 v[80:83], v[160:163], v[12:15], v[80:83]
    buffer_load_dwordx4 v[52:55], v6, s[16:19], s82 offen offset:3072 sc1
    v_mfma_f32_16x16x32_bf16 v[84:87], v[164:167], v[12:15], v[84:87]
    ds_write_b128 v62, v[72:75] offset:2048
    v_mfma_f32_16x16x32_bf16 v[88:91], v[168:171], v[12:15], v[88:91]
    ds_write_b128 v63, v[76:79] offset:3072
    v_mfma_f32_16x16x32_bf16 v[92:95], v[172:175], v[12:15], v[92:95]
    s_waitcnt vmcnt(9)
    v_mfma_f32_16x16x32_bf16 v[80:83], v[176:179], v[16:19], v[80:83]
    buffer_load_dwordx4 v[56:59], v7, s[16:19], s82 offen offset:2048 sc1
    v_mfma_f32_16x16x32_bf16 v[84:87], v[180:183], v[16:19], v[84:87]
    v_mfma_f32_16x16x32_bf16 v[88:91], v[184:187], v[16:19], v[88:91]
    v_mfma_f32_16x16x32_bf16 v[92:95], v[188:191], v[16:19], v[92:95]
    s_waitcnt lgkmcnt(0)
    s_barrier
    s_waitcnt vmcnt(9)
    v_mfma_f32_16x16x32_bf16 v[80:83], v[192:195], v[20:23], v[80:83]
    buffer_load_dwordx4 v[8:11], v6, s[16:19], s83 offen offset:3072 sc1
    v_mfma_f32_16x16x32_bf16 v[84:87], v[196:199], v[20:23], v[84:87]
    v_mfma_f32_16x16x32_bf16 v[88:91], v[200:203], v[20:23], v[88:91]
    v_mfma_f32_16x16x32_bf16 v[92:95], v[204:207], v[20:23], v[92:95]
    s_waitcnt vmcnt(9)
    v_mfma_f32_16x16x32_bf16 v[80:83], v[208:211], v[24:27], v[80:83]
    buffer_load_dwordx4 v[12:15], v7, s[16:19], s83 offen offset:2048 sc1
    v_mfma_f32_16x16x32_bf16 v[84:87], v[212:215], v[24:27], v[84:87]
    v_mfma_f32_16x16x32_bf16 v[88:91], v[216:219], v[24:27], v[88:91]
    v_mfma_f32_16x16x32_bf16 v[92:95], v[220:223], v[24:27], v[92:95]
    s_waitcnt vmcnt(9)
    v_mfma_f32_16x16x32_bf16 v[96:99], v[128:131], v[28:31], v[96:99]
    buffer_load_dwordx4 v[16:19], v6, s[16:19], s84 offen offset:3072 sc1
    v_mfma_f32_16x16x32_bf16 v[100:103], v[132:135], v[28:31], v[100:103]
    v_mfma_f32_16x16x32_bf16 v[104:107], v[136:139], v[28:31], v[104:107]
    v_mfma_f32_16x16x32_bf16 v[108:111], v[140:143], v[28:31], v[108:111]
    s_waitcnt vmcnt(9)
    v_mfma_f32_16x16x32_bf16 v[96:99], v[144:147], v[32:35], v[96:99]
    buffer_load_dwordx4 v[20:23], v7, s[16:19], s84 offen offset:2048 sc1
    v_mfma_f32_16x16x32_bf16 v[100:103], v[148:151], v[32:35], v[100:103]
    ds_write_b128 v60, v[80:83] offset:4096
    v_mfma_f32_16x16x32_bf16 v[104:107], v[152:155], v[32:35], v[104:107]
    ds_write_b128 v61, v[84:87] offset:5120
    v_mfma_f32_16x16x32_bf16 v[108:111], v[156:159], v[32:35], v[108:111]
    s_waitcnt vmcnt(9)
    v_mfma_f32_16x16x32_bf16 v[96:99], v[160:163], v[36:39], v[96:99]
    v_mfma_f32_16x16x32_bf16 v[100:103], v[164:167], v[36:39], v[100:103]
    ds_write_b128 v62, v[88:91] offset:6144
    v_mfma_f32_16x16x32_bf16 v[104:107], v[168:171], v[36:39], v[104:107]
    ds_write_b128 v63, v[92:95] offset:7168
    v_mfma_f32_16x16x32_bf16 v[108:111], v[172:175], v[36:39], v[108:111]
    s_waitcnt vmcnt(8)
    v_mfma_f32_16x16x32_bf16 v[96:99], v[176:179], v[40:43], v[96:99]
    v_mfma_f32_16x16x32_bf16 v[100:103], v[180:183], v[40:43], v[100:103]
    v_mfma_f32_16x16x32_bf16 v[104:107], v[184:187], v[40:43], v[104:107]
    v_mfma_f32_16x16x32_bf16 v[108:111], v[188:191], v[40:43], v[108:111]
    s_waitcnt lgkmcnt(0)
    s_barrier
    s_waitcnt vmcnt(7)
    v_mfma_f32_16x16x32_bf16 v[96:99], v[192:195], v[44:47], v[96:99]
    v_mfma_f32_16x16x32_bf16 v[100:103], v[196:199], v[44:47], v[100:103]
    v_mfma_f32_16x16x32_bf16 v[104:107], v[200:203], v[44:47], v[104:107]
    v_mfma_f32_16x16x32_bf16 v[108:111], v[204:207], v[44:47], v[108:111]
    s_waitcnt vmcnt(6)
    v_mfma_f32_16x16x32_bf16 v[96:99], v[208:211], v[48:51], v[96:99]
    v_mfma_f32_16x16x32_bf16 v[100:103], v[212:215], v[48:51], v[100:103]
    v_mfma_f32_16x16x32_bf16 v[104:107], v[216:219], v[48:51], v[104:107]
    v_mfma_f32_16x16x32_bf16 v[108:111], v[220:223], v[48:51], v[108:111]
    s_waitcnt vmcnt(5)
    v_mfma_f32_16x16x32_bf16 v[112:115], v[128:131], v[52:55], v[112:115]
    v_mfma_f32_16x16x32_bf16 v[116:119], v[132:135], v[52:55], v[116:119]
    v_mfma_f32_16x16x32_bf16 v[120:123], v[136:139], v[52:55], v[120:123]
    v_mfma_f32_16x16x32_bf16 v[124:127], v[140:143], v[52:55], v[124:127]
    s_waitcnt vmcnt(4)
    v_mfma_f32_16x16x32_bf16 v[112:115], v[144:147], v[56:59], v[112:115]
    v_mfma_f32_16x16x32_bf16 v[116:119], v[148:151], v[56:59], v[116:119]
    ds_write_b128 v60, v[96:99] offset:32768
    v_mfma_f32_16x16x32_bf16 v[120:123], v[152:155], v[56:59], v[120:123]
    ds_write_b128 v61, v[100:103] offset:33792
    v_mfma_f32_16x16x32_bf16 v[124:127], v[156:159], v[56:59], v[124:127]
    s_waitcnt vmcnt(3)
    v_mfma_f32_16x16x32_bf16 v[112:115], v[160:163], v[8:11], v[112:115]
    v_mfma_f32_16x16x32_bf16 v[116:119], v[164:167], v[8:11], v[116:119]
    ds_write_b128 v62, v[104:107] offset:34816
    v_mfma_f32_16x16x32_bf16 v[120:123], v[168:171], v[8:11], v[120:123]
    ds_write_b128 v63, v[108:111] offset:35840
    v_mfma_f32_16x16x32_bf16 v[124:127], v[172:175], v[8:11], v[124:127]
    s_waitcnt vmcnt(2)
    v_mfma_f32_16x16x32_bf16 v[112:115], v[176:179], v[12:15], v[112:115]
    v_mfma_f32_16x16x32_bf16 v[116:119], v[180:183], v[12:15], v[116:119]
    v_mfma_f32_16x16x32_bf16 v[120:123], v[184:187], v[12:15], v[120:123]
    v_mfma_f32_16x16x32_bf16 v[124:127], v[188:191], v[12:15], v[124:127]
    s_waitcnt lgkmcnt(0)
    s_barrier
    s_waitcnt vmcnt(1)
    v_mfma_f32_16x16x32_bf16 v[112:115], v[192:195], v[16:19], v[112:115]
    v_mfma_f32_16x16x32_bf16 v[116:119], v[196:199], v[16:19], v[116:119]
    v_mfma_f32_16x16x32_bf16 v[120:123], v[200:203], v[16:19], v[120:123]
    v_mfma_f32_16x16x32_bf16 v[124:127], v[204:207], v[16:19], v[124:127]
    s_waitcnt vmcnt(0)
    v_mfma_f32_16x16x32_bf16 v[112:115], v[208:211], v[20:23], v[112:115]
    v_mfma_f32_16x16x32_bf16 v[116:119], v[212:215], v[20:23], v[116:119]
    v_mfma_f32_16x16x32_bf16 v[120:123], v[216:219], v[20:23], v[120:123]
    v_mfma_f32_16x16x32_bf16 v[124:127], v[220:223], v[20:23], v[124:127]
    s_nop 4
    ds_write_b128 v60, v[112:115] offset:36864
    ds_write_b128 v61, v[116:119] offset:37888
    ds_write_b128 v62, v[120:123] offset:38912
    ds_write_b128 v63, v[124:127] offset:39936
    s_waitcnt lgkmcnt(0)
    s_barrier
    s_lshl3_add_u32 s20, s32, s33
    s_lshl_b32 s20, s20, 5
    s_add_u32 s20, s20, s31
    s_cmp_lg_u32 s20, 31
    s_cbranch_scc1 L_fin
    s_mov_b64 exec, 1
    buffer_store_dword v1, off, s[16:19], 0 sc1
L_fin:
    s_endpgm
L_retry_3:
    s_sub_u32 s77, s77, 1
    s_cmp_gt_i32 s77, 0
    s_cbranch_scc0 L_ok_2
    buffer_load_dwordx4 v[108:111], v121, s[16:19], s75 offen sc1
    buffer_load_dwordx4 v[104:107], v120, s[16:19], s75 offen sc1
    buffer_load_dwordx4 v[100:103], v119, s[16:19], s75 offen sc1
    buffer_load_dwordx4 v[96:99], v118, s[16:19], s75 offen sc1
    s_waitcnt vmcnt(0)
    s_branch L_chk_1
L_retry_6:
    s_sub_u32 s77, s77, 1
    s_cmp_gt_i32 s77, 0
    s_cbranch_scc0 L_ok_5
    s_load_dwordx8 s[44:51], s[42:43], 0 glc
    s_branch L_chk_4
L_retry_9:
    s_sub_u32 s77, s77, 1
    s_cmp_gt_i32 s77, 0
    s_cbranch_scc0 L_ok_8
    buffer_load_dwordx2 v[42:43], v40, s[16:19], s78 offen sc1
    s_waitcnt vmcnt(0)
    s_branch L_chk_7
L_light_12:
    s_waitcnt vmcnt(0)
    s_branch L_heavy_13
L_retry_16:
    s_sub_u32 s77, s77, 1
    s_cmp_gt_i32 s77, 0
    s_cbranch_scc0 L_ok_15
    s_load_dwordx8 s[8:15], s[42:43], 0 glc
    s_branch L_chk_14
L_retry_19:
    s_sub_u32 s77, s77, 1
    s_cmp_gt_i32 s77, 0
    s_cbranch_scc0 L_ok_18
    s_load_dwordx8 s[8:15], s[42:43], 128 glc
    s_branch L_chk_17
L_end:
    s_endpgm

.section .rodata,"a"
.p2align 6
.amdhsa_kernel recurrent_scan__ssm_conv_s5__dense_activation_mish__prompt_kernel
  .amdhsa_next_free_vgpr 256
  .amdhsa_next_free_sgpr 102
  .amdhsa_accum_offset 256
  .amdhsa_group_segment_fixed_size 0
  .amdhsa_kernarg_size 128
  .amdhsa_user_sgpr_count 2
  .amdhsa_user_sgpr_kernarg_segment_ptr 1
  .amdhsa_system_sgpr_workgroup_id_x 1
.end_amdhsa_kernel
```
